```python
import torch

def _softmax(x, axis=-1):
    return torch.softmax(x, dim=axis)
def _gelu(x):
    return torch.nn.functional.gelu(x, approximate="tanh")
def _silu(x):
    return torch.nn.functional.silu(x)
def _sigmoid(x):
    return torch.sigmoid(x)
def _layernorm(x, axis=-1, eps=1e-5):
    m = x.mean(dim=axis, keepdim=True)
    v = x.var(dim=axis, keepdim=True, unbiased=False)
    return (x - m) / torch.sqrt(v + eps)
def _scatter_add(tgt, idx, src, axis=0):
    return tgt.clone().index_add_(axis, idx, src)
def _segment_sum(src, seg, n):
    out = torch.zeros((n,) + src.shape[1:], dtype=src.dtype)
    return out.index_add_(0, seg, src)
def _pad(x, pw):
    flat = tuple(v for pair in reversed(pw) for v in pair)
    return torch.nn.functional.pad(x, flat)

kernel_name = 'standalone__mha_block_cached__sampling'

def setup_inputs():

    _w = (lambda a: (lambda t: t.to(torch.bfloat16) if t.is_floating_point() else t)(torch.as_tensor(a)))
    B, Sq, D = 8, 8, 512
    H, Sk, Dh = 32, 4096, 128
    return {
        "x": _w((lambda *s: torch.randn(*s, dtype=torch.bfloat16) * 0.8)(B, Sq, D)),
        "k_cache": _w((lambda *s: torch.randn(*s, dtype=torch.bfloat16) * 0.8)(B, H, Sk, Dh)),
        "v_cache": _w((lambda *s: torch.randn(*s, dtype=torch.bfloat16) * 0.05)(B, H, Sk, Dh)),
        "wq": _w((lambda *s: torch.randn(*s, dtype=torch.bfloat16) * 0.8)(D, H * Dh) * (D ** -0.5)),
        "wo": _w((lambda *s: torch.randn(*s, dtype=torch.bfloat16) * 0.05)(H * Dh, D) * ((H * Dh) ** -0.5)),
    }

def reference(x, k_cache, v_cache, wq, wo):
    B, Sq, D = x.shape
    H, Dh = 32, 128
    q = (lambda x, *d: x.permute(*d))((x @ wq).reshape(B, Sq, H, Dh), 0, 2, 1, 3)
    scores = torch.einsum("bhqd,bhkd->bhqk", q, k_cache) * (Dh ** -0.5)
    p = _softmax(scores, axis=-1)
    o = torch.einsum("bhqk,bhkd->bhqd", p, v_cache)
    return (lambda x, *d: x.permute(*d))(o, 0, 2, 1, 3).reshape(B, Sq, H * Dh) @ wo
```

```asm
; @launch grid=(256,1,1) block=(512,1,1) lds=147776
.amdgcn_target "amdgcn-amd-amdhsa--gfx950"
.text
.globl standalone__mha_block_cached__sampling_kernel
.p2align 8
.type standalone__mha_block_cached__sampling_kernel,@function
standalone__mha_block_cached__sampling_kernel:
  s_cmp_ge_u32 s2, 256
  s_cbranch_scc1 L_end
  s_load_dwordx16 s[4:19], s[0:1], 0
  v_lshrrev_b32 v1, 6, v0
  v_and_b32 v2, 63, v0
  v_readfirstlane_b32 s52, v1
  s_lshr_b32 s53, s2, 5
  s_bfe_u32 s54, s2, 0x30000
  s_lshl_b32 s54, s54, 2
  s_bfe_u32 s3, s2, 0x20003
  s_or_b32 s54, s54, s3
  s_lshl_b32 s2, s53, 5
  s_or_b32 s2, s2, s54
  s_mov_b32 s64, 0x05040100
  s_mov_b32 s65, 0x07060302
  s_cmp_ge_u32 s52, 4
  s_cbranch_scc1 L_proj
  s_lshl_b32 s3, s2, 20
  v_lshlrev_b32 v0, 4, v2
  v_and_b32 v4, 48, v2
  v_xor_b32 v8, v0, v4
  v_xor_b32 v9, 64, v8
  v_xor_b32 v10, 128, v8
  v_xor_b32 v11, 192, v8
  s_lshl_b32 s55, s52, 13
  s_add_u32 s56, s55, 4096
  s_mov_b32 s57, s55
  s_mov_b32 s58, s56
  s_lshl_b32 s78, s52, 15
  s_mov_b32 s22, 0x100000
  s_mov_b32 s23, 0x20000
  s_waitcnt lgkmcnt(0)
  s_add_u32 s20, s6, s3
  s_addc_u32 s21, s7, 0
  s_mov_b32 m0, s78
  s_nop 0
  buffer_load_dwordx4 v8, s[20:23], s55 offen offset:0 nt lds
  buffer_load_dwordx4 v9, s[20:23], s55 offen offset:1024 nt lds
  buffer_load_dwordx4 v10, s[20:23], s55 offen offset:2048 nt lds
  buffer_load_dwordx4 v11, s[20:23], s55 offen offset:3072 nt lds
  s_add_u32 s55, s55, 32768
  s_add_u32 m0, s78, 4096
  s_nop 0
  buffer_load_dwordx4 v8, s[20:23], s56 offen offset:0 nt lds
  s_branch L_srest
L_proj:
  s_memrealtime s[48:49]
  s_sub_u32 s52, s52, 4
  v_and_b32 v6, 15, v2
  v_lshrrev_b32 v7, 4, v2
  v_lshlrev_b32 v3, 16, v7
  v_lshl_add_u32 v3, v6, 4, v3
  v_lshlrev_b32 v4, 10, v6
  v_lshl_add_u32 v4, v7, 4, v4
  s_lshl_b32 s3, s53, 13
  s_lshl_b32 s67, s54, 8
  s_mov_b32 s30, 8192
  s_mov_b32 s31, 0x20000
  s_sub_u32 s34, 0x400000, s67
  s_mov_b32 s35, 0x20000
  s_lshl_b32 s66, s52, 20
  s_lshl_b32 s55, s52, 8
  v_lshrrev_b32 v8, 1, v2
  v_lshlrev_b32 v8, 13, v8
  v_and_b32 v9, 1, v2
  v_lshl_add_u32 v8, v9, 7, v8
  s_lshl_b32 s56, s53, 17
  s_add_u32 s56, s56, s66
  v_mov_b64 v[224:225], -1
  v_mov_b64 v[226:227], -1
  v_lshlrev_b32 v5, 4, v2
  s_lshl_b32 s57, s2, 13
  s_lshl_b32 s58, s52, 11
  s_add_u32 s57, s57, s58
  s_add_u32 s57, s57, 0x100000
  s_mov_b32 s42, 0x300000
  s_mov_b32 s43, 0x20000
  s_waitcnt lgkmcnt(0)
  s_mov_b32 s40, s18
  s_mov_b32 s41, s19
  buffer_store_dwordx4 v[224:227], v5, s[40:43], s57 offen offset:0 sc1
  buffer_store_dwordx4 v[224:227], v5, s[40:43], s57 offen offset:1024 sc1
  s_add_u32 s32, s10, s67
  s_addc_u32 s33, s11, 0
  s_add_u32 s28, s4, s3
  s_addc_u32 s29, s5, 0
  s_mov_b32 exec_hi, 0
  buffer_load_dword v9, v8, s[32:35], s56 offen
  s_mov_b64 exec, -1
  buffer_load_dwordx4 v[12:15], v4, s[28:31], s55 offen offset:0
  buffer_load_dwordx4 v[16:19], v4, s[28:31], s55 offen offset:64
  buffer_load_dwordx4 v[20:23], v4, s[28:31], s55 offen offset:128
  buffer_load_dwordx4 v[24:27], v4, s[28:31], s55 offen offset:192
  buffer_load_dwordx4 v[96:99], v3, s[32:35], s66 offen
  s_add_u32 s66, s66, 8192
  buffer_load_dwordx4 v[100:103], v3, s[32:35], s66 offen
  s_add_u32 s66, s66, 8192
  buffer_load_dwordx4 v[104:107], v3, s[32:35], s66 offen
  s_add_u32 s66, s66, 8192
  buffer_load_dwordx4 v[108:111], v3, s[32:35], s66 offen
  s_add_u32 s66, s66, 8192
  s_branch L_prest
L_srest:
  s_add_u32 s24, s8, s3
  s_addc_u32 s25, s9, 0
  s_mov_b32 s26, 0x100000
  s_mov_b32 s27, 0x20000
  s_mov_b32 s62, 0x3fb8aa3b
  s_mov_b32 s63, 0xbfb8aa3b
  s_mov_b32 s98, 0x3db504f3
  s_mov_b32 s99, s98
  v_lshrrev_b32 v232, 4, v2
  v_and_b32 v233, 3, v2
  v_lshlrev_b32 v233, 2, v233
  v_bfe_u32 v234, v2, 2, 2
  v_or_b32 v233, v233, v234
  v_lshlrev_b32 v234, 2, v232
  v_xor_b32 v234, v234, v233
  v_lshlrev_b32 v12, 8, v233
  v_lshl_add_u32 v12, v234, 4, v12
  v_add_u32 v12, s78, v12
  v_xor_b32 v13, 16, v12
  v_xor_b32 v14, 32, v12
  v_xor_b32 v15, 48, v12
  s_waitcnt vmcnt(4)
  buffer_load_dwordx4 v9, s[20:23], s56 offen offset:1024 nt lds
  v_and_b32 v233, 7, v2
  v_lshl_add_u32 v1, v232, 3, v233
  v_lshlrev_b32 v1, 4, v1
  v_bfe_u32 v234, v2, 3, 1
  v_lshl_add_u32 v1, v234, 11, v1
  v_add_u32 v1, 131072, v1
  s_mov_b32 s40, s18
  s_mov_b32 s41, s19
  s_waitcnt vmcnt(4)
  buffer_load_dwordx4 v10, s[20:23], s56 offen offset:2048 nt lds
  s_mov_b32 s42, 0x300000
  s_mov_b32 s43, 0x20000
  s_lshl_b32 s3, s53, 13
  s_add_u32 s44, s14, s3
  s_addc_u32 s45, s15, 0
  s_mov_b32 s46, 8192
  s_mov_b32 s47, 0x20000
  s_lshl_b32 s66, s52, 3
  s_add_u32 s66, s66, 147456
  v_lshl_add_u32 v241, v233, 5, s66
  s_waitcnt vmcnt(4)
  buffer_load_dwordx4 v11, s[20:23], s56 offen offset:3072 nt lds
  s_add_u32 s56, s56, 32768
  s_lshl_b32 s66, s52, 12
  v_add_u32 v240, s66, v0
  v_lshrrev_b32 v4, 3, v2
  v_lshlrev_b32 v242, 8, v4
  v_lshl_add_u32 v242, v233, 4, v242
  s_lshl_b32 s66, s2, 13
  s_lshl_b32 s67, s52, 7
  s_add_u32 s66, s66, s67
  s_waitcnt vmcnt(4)
  s_add_u32 m0, s78, 8192
  s_nop 0
  buffer_load_dwordx4 v8, s[20:23], s55 offen offset:0 nt lds
  s_add_u32 s66, s66, 0x100000
  v_add_u32 v242, s66, v242
  v_lshlrev_b32 v243, 10, v233
  v_and_b32 v4, 16, v2
  v_lshl_add_u32 v243, v4, 1, v243
  v_lshrrev_b32 v4, 5, v2
  v_lshl_add_u32 v243, v4, 4, v243
  s_lshr_b32 s66, s54, 3
  s_waitcnt vmcnt(4)
  buffer_load_dwordx4 v9, s[20:23], s55 offen offset:1024 nt lds
  s_lshl_b32 s66, s66, 8
  s_and_b32 s67, s54, 1
  s_lshl_b32 s67, s67, 1
  s_add_u32 s67, s67, s52
  s_lshl_b32 s67, s67, 6
  s_add_u32 s66, s66, s67
  s_and_b32 s67, s54, 6
  s_lshl_b32 s67, s67, 1
  s_waitcnt vmcnt(4)
  buffer_load_dwordx4 v10, s[20:23], s55 offen offset:2048 nt lds
  s_add_u32 s66, s66, s67
  v_add_u32 v243, s66, v243
  v_and_b32 v4, 15, v2
  v_and_b32 v5, 1, v2
  v_lshlrev_b32 v5, 4, v5
  v_mov_b32 v234, 0x3f80
  v_lshlrev_b32 v5, v5, v234
  v_lshrrev_b32 v4, 1, v4
  s_waitcnt vmcnt(4)
  buffer_load_dwordx4 v11, s[20:23], s55 offen offset:3072 nt lds
  s_add_u32 s55, s55, 32768
  v_cmp_eq_u32 vcc, 0, v4
  s_nop 1
  v_cndmask_b32 v244, 0, v5, vcc
  v_cmp_eq_u32 vcc, 1, v4
  s_nop 1
  v_cndmask_b32 v245, 0, v5, vcc
  v_cmp_eq_u32 vcc, 2, v4
  s_nop 1
  v_cndmask_b32 v246, 0, v5, vcc
  v_cmp_eq_u32 vcc, 3, v4
  s_nop 1
  v_cndmask_b32 v247, 0, v5, vcc
  v_mov_b64 v[16:17], 0
  v_mov_b64 v[18:19], 0
  v_mov_b64 v[20:21], 0
  v_mov_b64 v[22:23], 0
  s_waitcnt vmcnt(4)
  s_add_u32 m0, s78, 12288
  s_nop 0
  buffer_load_dwordx4 v8, s[20:23], s56 offen offset:0 nt lds
  ds_read_b128 v[48:51], v12 offset:0
  ds_read_b128 v[52:55], v13 offset:0
  ds_read_b128 v[56:59], v14 offset:0
  ds_read_b128 v[60:63], v15 offset:0
  ds_read_b128 v[64:67], v12 offset:4096
  ds_read_b128 v[68:71], v13 offset:4096
  ds_read_b128 v[72:75], v14 offset:4096
  ds_read_b128 v[76:79], v15 offset:4096
  s_waitcnt vmcnt(4)
  buffer_load_dwordx4 v9, s[20:23], s56 offen offset:1024 nt lds
  v_mov_b64 v[24:25], 0
  v_mov_b64 v[26:27], 0
  v_mov_b64 v[28:29], 0
  v_mov_b64 v[30:31], 0
  v_mov_b64 v[32:33], 0
  v_mov_b64 v[34:35], 0
  v_mov_b64 v[36:37], 0
  v_mov_b64 v[38:39], 0
  s_waitcnt vmcnt(4)
  buffer_load_dwordx4 v10, s[20:23], s56 offen offset:2048 nt lds
  v_mov_b64 v[40:41], 0
  v_mov_b64 v[42:43], 0
  v_mov_b64 v[44:45], 0
  v_mov_b64 v[46:47], 0
  v_mov_b32 v6, 0xff7fffff
  s_waitcnt vmcnt(4)
  buffer_load_dwordx4 v11, s[20:23], s56 offen offset:3072 nt lds
  s_add_u32 s56, s56, 32768
  s_waitcnt vmcnt(4)
  s_add_u32 m0, s78, 16384
  s_nop 0
  buffer_load_dwordx4 v8, s[20:23], s55 offen offset:0 nt lds
  s_waitcnt vmcnt(4)
  buffer_load_dwordx4 v9, s[20:23], s55 offen offset:1024 nt lds
  s_waitcnt vmcnt(4)
  buffer_load_dwordx4 v10, s[20:23], s55 offen offset:2048 nt lds
  s_waitcnt vmcnt(4)
  buffer_load_dwordx4 v11, s[20:23], s55 offen offset:3072 nt lds
  s_add_u32 s55, s55, 32768
  s_waitcnt vmcnt(4)
  s_add_u32 m0, s78, 20480
  s_nop 0
  buffer_load_dwordx4 v8, s[20:23], s56 offen offset:0 nt lds
  ds_read_b128 v[80:83], v12 offset:8192
  ds_read_b128 v[84:87], v13 offset:8192
  ds_read_b128 v[88:91], v14 offset:8192
  ds_read_b128 v[92:95], v15 offset:8192
  ds_read_b128 v[96:99], v12 offset:12288
  ds_read_b128 v[100:103], v13 offset:12288
  ds_read_b128 v[104:107], v14 offset:12288
  ds_read_b128 v[108:111], v15 offset:12288
  s_waitcnt vmcnt(4)
  buffer_load_dwordx4 v9, s[20:23], s56 offen offset:1024 nt lds
  s_waitcnt vmcnt(4)
  buffer_load_dwordx4 v10, s[20:23], s56 offen offset:2048 nt lds
  s_waitcnt vmcnt(4)
  buffer_load_dwordx4 v11, s[20:23], s56 offen offset:3072 nt lds
  s_add_u32 s56, s56, 32768
  s_waitcnt vmcnt(4)
  s_add_u32 m0, s78, 24576
  s_nop 0
  buffer_load_dwordx4 v8, s[20:23], s55 offen offset:0 nt lds
  s_waitcnt vmcnt(4)
  buffer_load_dwordx4 v9, s[20:23], s55 offen offset:1024 nt lds
  s_waitcnt vmcnt(4)
  buffer_load_dwordx4 v10, s[20:23], s55 offen offset:2048 nt lds
  s_waitcnt vmcnt(4)
  buffer_load_dwordx4 v11, s[20:23], s55 offen offset:3072 nt lds
  s_add_u32 s55, s55, 32768
  s_waitcnt vmcnt(4)
  s_add_u32 m0, s78, 28672
  s_nop 0
  buffer_load_dwordx4 v8, s[20:23], s56 offen offset:0 nt lds
  ds_read_b128 v[112:115], v12 offset:16384
  ds_read_b128 v[116:119], v13 offset:16384
  ds_read_b128 v[120:123], v14 offset:16384
  ds_read_b128 v[124:127], v15 offset:16384
  ds_read_b128 v[128:131], v12 offset:20480
  ds_read_b128 v[132:135], v13 offset:20480
  ds_read_b128 v[136:139], v14 offset:20480
  ds_read_b128 v[140:143], v15 offset:20480
  s_waitcnt vmcnt(4)
  buffer_load_dwordx4 v9, s[20:23], s56 offen offset:1024 nt lds
  s_waitcnt vmcnt(4)
  buffer_load_dwordx4 v10, s[20:23], s56 offen offset:2048 nt lds
  s_waitcnt vmcnt(4)
  buffer_load_dwordx4 v11, s[20:23], s56 offen offset:3072 nt lds
  s_add_u32 s56, s56, 32768
  s_waitcnt lgkmcnt(0)
  s_waitcnt vmcnt(4)
  s_mov_b32 m0, s78
  s_nop 0
  buffer_load_dwordx4 v8, s[20:23], s55 offen offset:0 nt lds
  s_waitcnt vmcnt(4)
  buffer_load_dwordx4 v9, s[20:23], s55 offen offset:1024 nt lds
  s_waitcnt vmcnt(4)
  buffer_load_dwordx4 v10, s[20:23], s55 offen offset:2048 nt lds
  s_waitcnt vmcnt(4)
  buffer_load_dwordx4 v11, s[20:23], s55 offen offset:3072 nt lds
  s_add_u32 s55, s55, 32768
  s_waitcnt vmcnt(4)
  s_add_u32 m0, s78, 4096
  s_nop 0
  buffer_load_dwordx4 v8, s[20:23], s56 offen offset:0 nt lds
  ds_read_b128 v[144:147], v12 offset:24576
  ds_read_b128 v[148:151], v13 offset:24576
  ds_read_b128 v[152:155], v14 offset:24576
  ds_read_b128 v[156:159], v15 offset:24576
  ds_read_b128 v[160:163], v12 offset:28672
  ds_read_b128 v[164:167], v13 offset:28672
  ds_read_b128 v[168:171], v14 offset:28672
  ds_read_b128 v[172:175], v15 offset:28672
  s_waitcnt vmcnt(4)
  buffer_load_dwordx4 v9, s[20:23], s56 offen offset:1024 nt lds
  s_waitcnt vmcnt(4)
  buffer_load_dwordx4 v10, s[20:23], s56 offen offset:2048 nt lds
  s_waitcnt vmcnt(4)
  buffer_load_dwordx4 v11, s[20:23], s56 offen offset:3072 nt lds
  s_add_u32 s56, s56, 32768
  s_waitcnt lgkmcnt(0)
  s_waitcnt vmcnt(4)
  s_add_u32 m0, s78, 8192
  s_nop 0
  buffer_load_dwordx4 v8, s[20:23], s55 offen offset:0 nt lds
  s_waitcnt vmcnt(4)
  buffer_load_dwordx4 v9, s[20:23], s55 offen offset:1024 nt lds
  s_waitcnt vmcnt(4)
  buffer_load_dwordx4 v10, s[20:23], s55 offen offset:2048 nt lds
  s_waitcnt vmcnt(4)
  buffer_load_dwordx4 v11, s[20:23], s55 offen offset:3072 nt lds
  s_add_u32 s55, s55, 32768
  s_waitcnt vmcnt(4)
  s_add_u32 m0, s78, 12288
  s_nop 0
  buffer_load_dwordx4 v8, s[20:23], s56 offen offset:0 nt lds
  ds_read_b128 v[176:179], v12 offset:0
  ds_read_b128 v[180:183], v13 offset:0
  ds_read_b128 v[184:187], v14 offset:0
  ds_read_b128 v[188:191], v15 offset:0
  ds_read_b128 v[192:195], v12 offset:4096
  ds_read_b128 v[196:199], v13 offset:4096
  ds_read_b128 v[200:203], v14 offset:4096
  ds_read_b128 v[204:207], v15 offset:4096
  s_waitcnt vmcnt(4)
  buffer_load_dwordx4 v9, s[20:23], s56 offen offset:1024 nt lds
  s_waitcnt vmcnt(4)
  buffer_load_dwordx4 v10, s[20:23], s56 offen offset:2048 nt lds
  s_waitcnt vmcnt(4)
  buffer_load_dwordx4 v11, s[20:23], s56 offen offset:3072 nt lds
  s_add_u32 s56, s56, 32768
  s_waitcnt lgkmcnt(0)
  s_waitcnt vmcnt(4)
  s_add_u32 m0, s78, 16384
  s_nop 0
  buffer_load_dwordx4 v8, s[20:23], s55 offen offset:0 nt lds
  s_waitcnt vmcnt(4)
  buffer_load_dwordx4 v9, s[20:23], s55 offen offset:1024 nt lds
  s_waitcnt vmcnt(4)
  buffer_load_dwordx4 v10, s[20:23], s55 offen offset:2048 nt lds
  s_waitcnt vmcnt(4)
  buffer_load_dwordx4 v11, s[20:23], s55 offen offset:3072 nt lds
  s_add_u32 s55, s55, 32768
  s_waitcnt vmcnt(4)
  s_add_u32 m0, s78, 20480
  s_nop 0
  buffer_load_dwordx4 v8, s[20:23], s56 offen offset:0 nt lds
  s_waitcnt vmcnt(4)
  buffer_load_dwordx4 v9, s[20:23], s56 offen offset:1024 nt lds
  s_waitcnt vmcnt(4)
  buffer_load_dwordx4 v10, s[20:23], s56 offen offset:2048 nt lds
  s_waitcnt vmcnt(4)
  buffer_load_dwordx4 v11, s[20:23], s56 offen offset:3072 nt lds
  s_add_u32 s56, s56, 32768
  s_waitcnt lgkmcnt(0)
  s_waitcnt vmcnt(4)
  s_add_u32 m0, s78, 24576
  s_nop 0
  buffer_load_dwordx4 v8, s[20:23], s55 offen offset:0 nt lds
  s_waitcnt vmcnt(4)
  buffer_load_dwordx4 v9, s[20:23], s55 offen offset:1024 nt lds
  s_waitcnt vmcnt(4)
  buffer_load_dwordx4 v10, s[20:23], s55 offen offset:2048 nt lds
  s_waitcnt vmcnt(4)
  buffer_load_dwordx4 v11, s[20:23], s55 offen offset:3072 nt lds
  s_add_u32 s55, s55, 32768
  s_waitcnt vmcnt(4)
  s_add_u32 m0, s78, 28672
  s_nop 0
  buffer_load_dwordx4 v8, s[20:23], s56 offen offset:0 nt lds
  s_waitcnt vmcnt(4)
  buffer_load_dwordx4 v9, s[20:23], s56 offen offset:1024 nt lds
  s_waitcnt lgkmcnt(0)
  s_barrier
  s_waitcnt vmcnt(4)
  buffer_load_dwordx4 v10, s[20:23], s56 offen offset:2048 nt lds
  ds_read_b128 v[208:211], v1 offset:0
  ds_read_b128 v[212:215], v1 offset:512
  ds_read_b128 v[216:219], v1 offset:1024
  ds_read_b128 v[220:223], v1 offset:1536
  ds_read_b128 v[224:227], v1 offset:4096
  ds_read_b128 v[228:231], v1 offset:4608
  ds_read_b128 v[232:235], v1 offset:5120
  ds_read_b128 v[236:239], v1 offset:5632
  s_waitcnt lgkmcnt(0)
  v_pk_add_f32 v[208:209], v[208:209], v[224:225]
  v_pk_add_f32 v[210:211], v[210:211], v[226:227]
  v_pk_add_f32 v[212:213], v[212:213], v[228:229]
  v_pk_add_f32 v[214:215], v[214:215], v[230:231]
  v_pk_add_f32 v[216:217], v[216:217], v[232:233]
  v_pk_add_f32 v[218:219], v[218:219], v[234:235]
  v_pk_add_f32 v[220:221], v[220:221], v[236:237]
  v_pk_add_f32 v[222:223], v[222:223], v[238:239]
  ds_read_b128 v[224:227], v1 offset:8192
  ds_read_b128 v[228:231], v1 offset:8704
  ds_read_b128 v[232:235], v1 offset:9216
  ds_read_b128 v[236:239], v1 offset:9728
  s_waitcnt lgkmcnt(0)
  s_waitcnt vmcnt(4)
  buffer_load_dwordx4 v11, s[20:23], s56 offen offset:3072 nt lds
  s_add_u32 s56, s56, 32768
  v_pk_add_f32 v[208:209], v[208:209], v[224:225]
  v_pk_add_f32 v[210:211], v[210:211], v[226:227]
  v_pk_add_f32 v[212:213], v[212:213], v[228:229]
  v_pk_add_f32 v[214:215], v[214:215], v[230:231]
  v_pk_add_f32 v[216:217], v[216:217], v[232:233]
  v_pk_add_f32 v[218:219], v[218:219], v[234:235]
  v_pk_add_f32 v[220:221], v[220:221], v[236:237]
  v_pk_add_f32 v[222:223], v[222:223], v[238:239]
  ds_read_b128 v[224:227], v1 offset:12288
  ds_read_b128 v[228:231], v1 offset:12800
  ds_read_b128 v[232:235], v1 offset:13312
  ds_read_b128 v[236:239], v1 offset:13824
  s_waitcnt lgkmcnt(0)
  v_pk_add_f32 v[208:209], v[208:209], v[224:225]
  v_pk_add_f32 v[210:211], v[210:211], v[226:227]
  v_pk_add_f32 v[212:213], v[212:213], v[228:229]
  v_pk_add_f32 v[214:215], v[214:215], v[230:231]
  v_pk_add_f32 v[216:217], v[216:217], v[232:233]
  v_pk_add_f32 v[218:219], v[218:219], v[234:235]
  v_pk_add_f32 v[220:221], v[220:221], v[236:237]
  v_pk_add_f32 v[222:223], v[222:223], v[238:239]
  v_cvt_pk_bf16_f32 v248, v208, v212
  v_cvt_pk_bf16_f32 v249, v216, v220
  v_cvt_pk_bf16_f32 v250, v209, v213
  v_cvt_pk_bf16_f32 v251, v217, v221
  v_cvt_pk_bf16_f32 v252, v210, v214
  v_cvt_pk_bf16_f32 v253, v218, v222
  v_cvt_pk_bf16_f32 v254, v211, v215
  v_cvt_pk_bf16_f32 v255, v219, v223
  s_nop 1
  v_mov_b32_dpp v16, v248 quad_perm:[0,1,2,3] row_mask:0xf bank_mask:0x3
  v_mov_b32_dpp v18, v248 row_ror:8 row_mask:0xf bank_mask:0x3
  v_mov_b32_dpp v17, v249 quad_perm:[0,1,2,3] row_mask:0xf bank_mask:0x3
  v_mov_b32_dpp v19, v249 row_ror:8 row_mask:0xf bank_mask:0x3
  s_waitcnt vmcnt(4)
  s_mov_b32 m0, s78
  s_nop 0
  buffer_load_dwordx4 v8, s[20:23], s55 offen offset:0 nt lds
  v_mov_b32_dpp v20, v250 quad_perm:[0,1,2,3] row_mask:0xf bank_mask:0x3
  v_mov_b32_dpp v22, v250 row_ror:8 row_mask:0xf bank_mask:0x3
  v_mov_b32_dpp v21, v251 quad_perm:[0,1,2,3] row_mask:0xf bank_mask:0x3
  v_mov_b32_dpp v23, v251 row_ror:8 row_mask:0xf bank_mask:0x3
  v_mov_b32_dpp v24, v252 quad_perm:[0,1,2,3] row_mask:0xf bank_mask:0x3
  v_mov_b32_dpp v26, v252 row_ror:8 row_mask:0xf bank_mask:0x3
  v_mov_b32_dpp v25, v253 quad_perm:[0,1,2,3] row_mask:0xf bank_mask:0x3
  v_mov_b32_dpp v27, v253 row_ror:8 row_mask:0xf bank_mask:0x3
  v_mov_b32_dpp v28, v254 quad_perm:[0,1,2,3] row_mask:0xf bank_mask:0x3
  v_mov_b32_dpp v30, v254 row_ror:8 row_mask:0xf bank_mask:0x3
  v_mov_b32_dpp v29, v255 quad_perm:[0,1,2,3] row_mask:0xf bank_mask:0x3
  v_mov_b32_dpp v31, v255 row_ror:8 row_mask:0xf bank_mask:0x3
  v_mov_b32_dpp v32, v248 row_ror:8 row_mask:0xf bank_mask:0xc
  v_mov_b32_dpp v34, v248 quad_perm:[0,1,2,3] row_mask:0xf bank_mask:0xc
  v_mov_b32_dpp v33, v249 row_ror:8 row_mask:0xf bank_mask:0xc
  v_mov_b32_dpp v35, v249 quad_perm:[0,1,2,3] row_mask:0xf bank_mask:0xc
  v_mov_b32_dpp v36, v250 row_ror:8 row_mask:0xf bank_mask:0xc
  v_mov_b32_dpp v38, v250 quad_perm:[0,1,2,3] row_mask:0xf bank_mask:0xc
  v_mov_b32_dpp v37, v251 row_ror:8 row_mask:0xf bank_mask:0xc
  v_mov_b32_dpp v39, v251 quad_perm:[0,1,2,3] row_mask:0xf bank_mask:0xc
  v_mov_b32_dpp v40, v252 row_ror:8 row_mask:0xf bank_mask:0xc
  v_mov_b32_dpp v42, v252 quad_perm:[0,1,2,3] row_mask:0xf bank_mask:0xc
  v_mov_b32_dpp v41, v253 row_ror:8 row_mask:0xf bank_mask:0xc
  v_mov_b32_dpp v43, v253 quad_perm:[0,1,2,3] row_mask:0xf bank_mask:0xc
  v_mov_b32_dpp v44, v254 row_ror:8 row_mask:0xf bank_mask:0xc
  v_mov_b32_dpp v46, v254 quad_perm:[0,1,2,3] row_mask:0xf bank_mask:0xc
  v_mov_b32_dpp v45, v255 row_ror:8 row_mask:0xf bank_mask:0xc
  v_mov_b32_dpp v47, v255 quad_perm:[0,1,2,3] row_mask:0xf bank_mask:0xc
  v_mov_b32 v1, 147712
  s_nop 0
  v_mfma_f32_16x16x32_bf16 v[208:211], v[48:51], v[16:19], 0
  v_mfma_f32_16x16x32_bf16 v[208:211], v[52:55], v[20:23], v[208:211]
  v_mfma_f32_16x16x32_bf16 v[208:211], v[56:59], v[24:27], v[208:211]
  v_mfma_f32_16x16x32_bf16 v[208:211], v[60:63], v[28:31], v[208:211]
  v_mfma_f32_16x16x32_bf16 v[212:215], v[64:67], v[16:19], 0
  v_mfma_f32_16x16x32_bf16 v[212:215], v[68:71], v[20:23], v[212:215]
  v_mfma_f32_16x16x32_bf16 v[212:215], v[72:75], v[24:27], v[212:215]
  v_mfma_f32_16x16x32_bf16 v[212:215], v[76:79], v[28:31], v[212:215]
  v_mfma_f32_16x16x32_bf16 v[208:211], v[80:83], v[32:35], v[208:211]
  s_waitcnt vmcnt(4)
  buffer_load_dwordx4 v9, s[20:23], s55 offen offset:1024 nt lds
  v_mfma_f32_16x16x32_bf16 v[208:211], v[84:87], v[36:39], v[208:211]
  v_mfma_f32_16x16x32_bf16 v[208:211], v[88:91], v[40:43], v[208:211]
  v_mfma_f32_16x16x32_bf16 v[208:211], v[92:95], v[44:47], v[208:211]
  v_mfma_f32_16x16x32_bf16 v[212:215], v[96:99], v[32:35], v[212:215]
  v_mfma_f32_16x16x32_bf16 v[212:215], v[100:103], v[36:39], v[212:215]
  v_mfma_f32_16x16x32_bf16 v[212:215], v[104:107], v[40:43], v[212:215]
  v_mfma_f32_16x16x32_bf16 v[212:215], v[108:111], v[44:47], v[212:215]
  v_mfma_f32_16x16x32_bf16 v[216:219], v[112:115], v[16:19], 0
  v_mfma_f32_16x16x32_bf16 v[216:219], v[116:119], v[20:23], v[216:219]
  v_mfma_f32_16x16x32_bf16 v[216:219], v[120:123], v[24:27], v[216:219]
  v_mfma_f32_16x16x32_bf16 v[216:219], v[124:127], v[28:31], v[216:219]
  v_mfma_f32_16x16x32_bf16 v[220:223], v[128:131], v[16:19], 0
  v_mfma_f32_16x16x32_bf16 v[220:223], v[132:135], v[20:23], v[220:223]
  v_mfma_f32_16x16x32_bf16 v[220:223], v[136:139], v[24:27], v[220:223]
  v_mfma_f32_16x16x32_bf16 v[220:223], v[140:143], v[28:31], v[220:223]
  v_mfma_f32_16x16x32_bf16 v[216:219], v[144:147], v[32:35], v[216:219]
  v_mfma_f32_16x16x32_bf16 v[216:219], v[148:151], v[36:39], v[216:219]
  v_mfma_f32_16x16x32_bf16 v[216:219], v[152:155], v[40:43], v[216:219]
  s_waitcnt vmcnt(4)
  buffer_load_dwordx4 v10, s[20:23], s55 offen offset:2048 nt lds
  v_mfma_f32_16x16x32_bf16 v[216:219], v[156:159], v[44:47], v[216:219]
  v_mfma_f32_16x16x32_bf16 v[220:223], v[160:163], v[32:35], v[220:223]
  v_mfma_f32_16x16x32_bf16 v[220:223], v[164:167], v[36:39], v[220:223]
  v_mfma_f32_16x16x32_bf16 v[220:223], v[168:171], v[40:43], v[220:223]
  v_mfma_f32_16x16x32_bf16 v[220:223], v[172:175], v[44:47], v[220:223]
  v_cvt_pk_bf16_f32 v4, v208, v209
  v_cvt_pk_bf16_f32 v5, v210, v211
  v_lshlrev_b32 v208, 16, v4
  v_and_b32 v209, 0xffff0000, v4
  v_lshlrev_b32 v210, 16, v5
  v_and_b32 v211, 0xffff0000, v5
  v_pk_mul_f32 v[208:209], v[208:209], s[98:99]
  v_pk_mul_f32 v[210:211], v[210:211], s[98:99]
  v_cvt_pk_bf16_f32 v4, v208, v209
  v_cvt_pk_bf16_f32 v5, v210, v211
  v_lshlrev_b32 v208, 16, v4
  v_and_b32 v209, 0xffff0000, v4
  v_lshlrev_b32 v210, 16, v5
  v_and_b32 v211, 0xffff0000, v5
  v_cvt_pk_bf16_f32 v4, v212, v213
  v_cvt_pk_bf16_f32 v5, v214, v215
  v_lshlrev_b32 v212, 16, v4
  v_and_b32 v213, 0xffff0000, v4
  v_lshlrev_b32 v214, 16, v5
  v_and_b32 v215, 0xffff0000, v5
  v_pk_mul_f32 v[212:213], v[212:213], s[98:99]
  v_pk_mul_f32 v[214:215], v[214:215], s[98:99]
  v_cvt_pk_bf16_f32 v4, v212, v213
  v_cvt_pk_bf16_f32 v5, v214, v215
  v_lshlrev_b32 v212, 16, v4
  v_and_b32 v213, 0xffff0000, v4
  v_lshlrev_b32 v214, 16, v5
  v_and_b32 v215, 0xffff0000, v5
  v_max3_f32 v6, v6, v208, v209
  v_max3_f32 v6, v6, v210, v211
  v_max3_f32 v6, v6, v212, v213
  v_max3_f32 v6, v6, v214, v215
  v_mfma_f32_16x16x32_bf16 v[224:227], v[176:179], v[16:19], 0
  v_mfma_f32_16x16x32_bf16 v[224:227], v[180:183], v[20:23], v[224:227]
  s_waitcnt vmcnt(4)
  buffer_load_dwordx4 v11, s[20:23], s55 offen offset:3072 nt lds
  s_add_u32 s55, s55, 32768
  v_mfma_f32_16x16x32_bf16 v[224:227], v[184:187], v[24:27], v[224:227]
  v_mfma_f32_16x16x32_bf16 v[224:227], v[188:191], v[28:31], v[224:227]
  v_mfma_f32_16x16x32_bf16 v[228:231], v[192:195], v[16:19], 0
  v_mfma_f32_16x16x32_bf16 v[228:231], v[196:199], v[20:23], v[228:231]
  v_mfma_f32_16x16x32_bf16 v[228:231], v[200:203], v[24:27], v[228:231]
  v_mfma_f32_16x16x32_bf16 v[228:231], v[204:207], v[28:31], v[228:231]
  ds_read_b128 v[48:51], v12 offset:8192
  ds_read_b128 v[52:55], v13 offset:8192
  ds_read_b128 v[56:59], v14 offset:8192
  ds_read_b128 v[60:63], v15 offset:8192
  ds_read_b128 v[64:67], v12 offset:12288
  ds_read_b128 v[68:71], v13 offset:12288
  ds_read_b128 v[72:75], v14 offset:12288
  ds_read_b128 v[76:79], v15 offset:12288
  v_cvt_pk_bf16_f32 v4, v216, v217
  v_cvt_pk_bf16_f32 v5, v218, v219
  v_lshlrev_b32 v216, 16, v4
  v_and_b32 v217, 0xffff0000, v4
  v_lshlrev_b32 v218, 16, v5
  v_and_b32 v219, 0xffff0000, v5
  v_pk_mul_f32 v[216:217], v[216:217], s[98:99]
  v_pk_mul_f32 v[218:219], v[218:219], s[98:99]
  v_cvt_pk_bf16_f32 v4, v216, v217
  v_cvt_pk_bf16_f32 v5, v218, v219
  v_lshlrev_b32 v216, 16, v4
  v_and_b32 v217, 0xffff0000, v4
  v_lshlrev_b32 v218, 16, v5
  v_and_b32 v219, 0xffff0000, v5
  s_waitcnt vmcnt(4)
  s_add_u32 m0, s78, 4096
  s_nop 0
  buffer_load_dwordx4 v8, s[20:23], s56 offen offset:0 nt lds
  v_cvt_pk_bf16_f32 v4, v220, v221
  v_cvt_pk_bf16_f32 v5, v222, v223
  v_lshlrev_b32 v220, 16, v4
  v_and_b32 v221, 0xffff0000, v4
  v_lshlrev_b32 v222, 16, v5
  v_and_b32 v223, 0xffff0000, v5
  v_pk_mul_f32 v[220:221], v[220:221], s[98:99]
  v_pk_mul_f32 v[222:223], v[222:223], s[98:99]
  v_cvt_pk_bf16_f32 v4, v220, v221
  v_cvt_pk_bf16_f32 v5, v222, v223
  v_lshlrev_b32 v220, 16, v4
  v_and_b32 v221, 0xffff0000, v4
  v_lshlrev_b32 v222, 16, v5
  v_and_b32 v223, 0xffff0000, v5
  v_max3_f32 v6, v6, v216, v217
  v_max3_f32 v6, v6, v218, v219
  v_max3_f32 v6, v6, v220, v221
  v_max3_f32 v6, v6, v222, v223
  s_waitcnt lgkmcnt(4)
  v_mfma_f32_16x16x32_bf16 v[224:227], v[48:51], v[32:35], v[224:227]
  v_mfma_f32_16x16x32_bf16 v[224:227], v[52:55], v[36:39], v[224:227]
  v_mfma_f32_16x16x32_bf16 v[224:227], v[56:59], v[40:43], v[224:227]
  v_mfma_f32_16x16x32_bf16 v[224:227], v[60:63], v[44:47], v[224:227]
  s_waitcnt lgkmcnt(3)
  v_mfma_f32_16x16x32_bf16 v[228:231], v[64:67], v[32:35], v[228:231]
  s_waitcnt lgkmcnt(2)
  v_mfma_f32_16x16x32_bf16 v[228:231], v[68:71], v[36:39], v[228:231]
  s_waitcnt vmcnt(4)
  buffer_load_dwordx4 v9, s[20:23], s56 offen offset:1024 nt lds
  s_waitcnt lgkmcnt(1)
  v_mfma_f32_16x16x32_bf16 v[228:231], v[72:75], v[40:43], v[228:231]
  s_waitcnt lgkmcnt(0)
  v_mfma_f32_16x16x32_bf16 v[228:231], v[76:79], v[44:47], v[228:231]
  ds_read_b128 v[48:51], v12 offset:16384
  ds_read_b128 v[52:55], v13 offset:16384
  ds_read_b128 v[56:59], v14 offset:16384
  ds_read_b128 v[60:63], v15 offset:16384
  ds_read_b128 v[64:67], v12 offset:20480
  ds_read_b128 v[68:71], v13 offset:20480
  ds_read_b128 v[72:75], v14 offset:20480
  ds_read_b128 v[76:79], v15 offset:20480
  s_waitcnt lgkmcnt(4)
  v_mfma_f32_16x16x32_bf16 v[232:235], v[48:51], v[16:19], 0
  v_mfma_f32_16x16x32_bf16 v[232:235], v[52:55], v[20:23], v[232:235]
  v_mfma_f32_16x16x32_bf16 v[232:235], v[56:59], v[24:27], v[232:235]
  s_waitcnt vmcnt(4)
  buffer_load_dwordx4 v10, s[20:23], s56 offen offset:2048 nt lds
  v_mfma_f32_16x16x32_bf16 v[232:235], v[60:63], v[28:31], v[232:235]
  s_waitcnt lgkmcnt(3)
  v_mfma_f32_16x16x32_bf16 v[236:239], v[64:67], v[16:19], 0
  s_waitcnt lgkmcnt(2)
  v_mfma_f32_16x16x32_bf16 v[236:239], v[68:71], v[20:23], v[236:239]
  s_waitcnt lgkmcnt(1)
  v_mfma_f32_16x16x32_bf16 v[236:239], v[72:75], v[24:27], v[236:239]
  s_waitcnt lgkmcnt(0)
  v_mfma_f32_16x16x32_bf16 v[236:239], v[76:79], v[28:31], v[236:239]
  ds_read_b128 v[48:51], v12 offset:24576
  ds_read_b128 v[52:55], v13 offset:24576
  ds_read_b128 v[56:59], v14 offset:24576
  ds_read_b128 v[60:63], v15 offset:24576
  ds_read_b128 v[64:67], v12 offset:28672
  ds_read_b128 v[68:71], v13 offset:28672
  s_waitcnt vmcnt(4)
  buffer_load_dwordx4 v11, s[20:23], s56 offen offset:3072 nt lds
  s_add_u32 s56, s56, 32768
  ds_read_b128 v[72:75], v14 offset:28672
  ds_read_b128 v[76:79], v15 offset:28672
  v_cvt_pk_bf16_f32 v4, v224, v225
  v_cvt_pk_bf16_f32 v5, v226, v227
  v_lshlrev_b32 v224, 16, v4
  v_and_b32 v225, 0xffff0000, v4
  v_lshlrev_b32 v226, 16, v5
  v_and_b32 v227, 0xffff0000, v5
  v_pk_mul_f32 v[224:225], v[224:225], s[98:99]
  v_pk_mul_f32 v[226:227], v[226:227], s[98:99]
  v_cvt_pk_bf16_f32 v4, v224, v225
  v_cvt_pk_bf16_f32 v5, v226, v227
  v_lshlrev_b32 v224, 16, v4
  v_and_b32 v225, 0xffff0000, v4
  v_lshlrev_b32 v226, 16, v5
  v_and_b32 v227, 0xffff0000, v5
  v_cvt_pk_bf16_f32 v4, v228, v229
  v_cvt_pk_bf16_f32 v5, v230, v231
  v_lshlrev_b32 v228, 16, v4
  v_and_b32 v229, 0xffff0000, v4
  v_lshlrev_b32 v230, 16, v5
  v_and_b32 v231, 0xffff0000, v5
  v_pk_mul_f32 v[228:229], v[228:229], s[98:99]
  v_pk_mul_f32 v[230:231], v[230:231], s[98:99]
  v_cvt_pk_bf16_f32 v4, v228, v229
  v_cvt_pk_bf16_f32 v5, v230, v231
  v_lshlrev_b32 v228, 16, v4
  v_and_b32 v229, 0xffff0000, v4
  v_lshlrev_b32 v230, 16, v5
  v_and_b32 v231, 0xffff0000, v5
  v_max3_f32 v6, v6, v224, v225
  v_max3_f32 v6, v6, v226, v227
  v_max3_f32 v6, v6, v228, v229
  v_max3_f32 v6, v6, v230, v231
  s_waitcnt lgkmcnt(4)
  v_mfma_f32_16x16x32_bf16 v[232:235], v[48:51], v[32:35], v[232:235]
  v_mfma_f32_16x16x32_bf16 v[232:235], v[52:55], v[36:39], v[232:235]
  v_mfma_f32_16x16x32_bf16 v[232:235], v[56:59], v[40:43], v[232:235]
  v_mfma_f32_16x16x32_bf16 v[232:235], v[60:63], v[44:47], v[232:235]
  s_waitcnt lgkmcnt(3)
  v_mfma_f32_16x16x32_bf16 v[236:239], v[64:67], v[32:35], v[236:239]
  s_waitcnt lgkmcnt(2)
  v_mfma_f32_16x16x32_bf16 v[236:239], v[68:71], v[36:39], v[236:239]
  s_waitcnt lgkmcnt(1)
  v_mfma_f32_16x16x32_bf16 v[236:239], v[72:75], v[40:43], v[236:239]
  s_waitcnt lgkmcnt(0)
  v_mfma_f32_16x16x32_bf16 v[236:239], v[76:79], v[44:47], v[236:239]
  s_mov_b32 s59, 2
  s_mov_b32 s50, 0
  s_mov_b64 vcc, 0
.p2align 6
L_ktop:
  s_barrier
  s_cmp_gt_i32 s50, 0
  s_cselect_b64 vcc, -1, 0
  s_subb_u32 s50, s50, 0
  s_waitcnt vmcnt(7)
  s_cbranch_vccnz L_go2
  s_waitcnt vmcnt(4)
L_go2:
  s_add_u32 m0, s78, 8192
  s_nop 0
  buffer_load_dwordx4 v8, s[20:23], s55 offen offset:0 nt lds
  s_waitcnt vmcnt(7)
  s_cbranch_vccnz L_go3
  s_waitcnt vmcnt(4)
L_go3:
  buffer_load_dwordx4 v9, s[20:23], s55 offen offset:1024 nt lds
  v_cvt_pk_bf16_f32 v4, v232, v233
  v_cvt_pk_bf16_f32 v5, v234, v235
  v_lshlrev_b32 v232, 16, v4
  v_and_b32 v233, 0xffff0000, v4
  v_lshlrev_b32 v234, 16, v5
  v_and_b32 v235, 0xffff0000, v5
  v_pk_mul_f32 v[232:233], v[232:233], s[98:99]
  v_pk_mul_f32 v[234:235], v[234:235], s[98:99]
  v_cvt_pk_bf16_f32 v4, v232, v233
  v_cvt_pk_bf16_f32 v5, v234, v235
  v_lshlrev_b32 v232, 16, v4
  v_and_b32 v233, 0xffff0000, v4
  v_lshlrev_b32 v234, 16, v5
  s_waitcnt vmcnt(7)
  s_cbranch_vccnz L_go4
  s_waitcnt vmcnt(4)
L_go4:
  buffer_load_dwordx4 v10, s[20:23], s55 offen offset:2048 nt lds
  v_and_b32 v235, 0xffff0000, v5
  v_cvt_pk_bf16_f32 v4, v236, v237
  v_cvt_pk_bf16_f32 v5, v238, v239
  v_lshlrev_b32 v236, 16, v4
  v_and_b32 v237, 0xffff0000, v4
  v_lshlrev_b32 v238, 16, v5
  v_and_b32 v239, 0xffff0000, v5
  v_pk_mul_f32 v[236:237], v[236:237], s[98:99]
  v_pk_mul_f32 v[238:239], v[238:239], s[98:99]
  v_cvt_pk_bf16_f32 v4, v236, v237
  v_cvt_pk_bf16_f32 v5, v238, v239
  v_lshlrev_b32 v236, 16, v4
  v_and_b32 v237, 0xffff0000, v4
  s_waitcnt vmcnt(7)
  s_cbranch_vccnz L_go5
  s_waitcnt vmcnt(4)
L_go5:
  buffer_load_dwordx4 v11, s[20:23], s55 offen offset:3072 nt lds
  s_add_u32 s55, s55, 32768
  ds_read_b128 v[48:51], v12 offset:0
  ds_read_b128 v[52:55], v13 offset:0
  ds_read_b128 v[56:59], v14 offset:0
  ds_read_b128 v[60:63], v15 offset:0
  v_lshlrev_b32 v238, 16, v5
  v_and_b32 v239, 0xffff0000, v5
  v_max3_f32 v6, v6, v232, v233
  v_max3_f32 v6, v6, v234, v235
  v_max3_f32 v6, v6, v236, v237
  v_max3_f32 v6, v6, v238, v239
  v_mov_b64 v[112:113], v[128:129]
  v_mov_b64 v[114:115], v[130:131]
  v_mov_b64 v[116:117], v[132:133]
  v_mov_b64 v[118:119], v[134:135]
  v_mov_b64 v[120:121], v[136:137]
  v_mov_b64 v[122:123], v[138:139]
  v_mov_b64 v[124:125], v[140:141]
  s_waitcnt vmcnt(7)
  s_cbranch_vccnz L_go6
  s_waitcnt vmcnt(4)
L_go6:
  s_add_u32 m0, s78, 12288
  s_nop 0
  buffer_load_dwordx4 v8, s[20:23], s56 offen offset:0 nt lds
  v_mov_b64 v[126:127], v[142:143]
  v_mov_b64 v[128:129], v[144:145]
  v_mov_b64 v[130:131], v[146:147]
  v_mov_b64 v[132:133], v[148:149]
  v_mov_b64 v[134:135], v[150:151]
  v_mov_b64 v[136:137], v[152:153]
  v_mov_b64 v[138:139], v[154:155]
  v_mov_b64 v[140:141], v[156:157]
  v_mov_b64 v[142:143], v[158:159]
  v_mov_b64 v[144:145], v[160:161]
  v_mov_b64 v[146:147], v[162:163]
  v_mov_b64 v[148:149], v[164:165]
  v_mov_b64 v[150:151], v[166:167]
  s_waitcnt vmcnt(7)
  s_cbranch_vccnz L_go7
  s_waitcnt vmcnt(4)
L_go7:
  buffer_load_dwordx4 v9, s[20:23], s56 offen offset:1024 nt lds
  v_mov_b64 v[152:153], v[168:169]
  v_mov_b64 v[154:155], v[170:171]
  v_mov_b64 v[156:157], v[172:173]
  v_mov_b64 v[158:159], v[174:175]
  v_mov_b64 v[160:161], v[176:177]
  v_mov_b64 v[162:163], v[178:179]
  v_mov_b64 v[164:165], v[180:181]
  v_mov_b64 v[166:167], v[182:183]
  v_mov_b64 v[168:169], v[184:185]
  v_mov_b64 v[170:171], v[186:187]
  v_mov_b64 v[172:173], v[188:189]
  v_mov_b64 v[174:175], v[190:191]
  v_mov_b64 v[176:177], v[192:193]
  s_waitcnt vmcnt(7)
  s_cbranch_vccnz L_go8
  s_waitcnt vmcnt(4)
L_go8:
  buffer_load_dwordx4 v10, s[20:23], s56 offen offset:2048 nt lds
  v_mov_b64 v[178:179], v[194:195]
  v_mov_b64 v[180:181], v[196:197]
  v_mov_b64 v[182:183], v[198:199]
  v_mov_b64 v[184:185], v[200:201]
  v_mov_b64 v[186:187], v[202:203]
  v_mov_b64 v[188:189], v[204:205]
  v_mov_b64 v[190:191], v[206:207]
  v_mov_b64 v[192:193], v[208:209]
  v_mov_b64 v[194:195], v[210:211]
  v_mov_b64 v[196:197], v[212:213]
  v_mov_b64 v[198:199], v[214:215]
  v_mov_b64 v[200:201], v[216:217]
  v_mov_b64 v[202:203], v[218:219]
  s_waitcnt vmcnt(7)
  s_cbranch_vccnz L_go9
  s_waitcnt vmcnt(4)
L_go9:
  buffer_load_dwordx4 v11, s[20:23], s56 offen offset:3072 nt lds
  s_add_u32 s56, s56, 32768
  v_mov_b64 v[204:205], v[220:221]
  v_mov_b64 v[206:207], v[222:223]
  v_mov_b64 v[208:209], v[224:225]
  v_mov_b64 v[210:211], v[226:227]
  v_mov_b64 v[212:213], v[228:229]
  v_mov_b64 v[214:215], v[230:231]
  v_mov_b64 v[216:217], v[232:233]
  v_mov_b64 v[218:219], v[234:235]
  v_mov_b64 v[220:221], v[236:237]
  v_mov_b64 v[222:223], v[238:239]
  ds_read_b128 v[64:67], v12 offset:4096
  ds_read_b128 v[68:71], v13 offset:4096
  ds_read_b128 v[72:75], v14 offset:4096
  ds_read_b128 v[76:79], v15 offset:4096
  s_waitcnt lgkmcnt(4)
  v_mfma_f32_16x16x32_bf16 v[224:227], v[48:51], v[16:19], 0
  v_mfma_f32_16x16x32_bf16 v[224:227], v[52:55], v[20:23], v[224:227]
  v_mfma_f32_16x16x32_bf16 v[224:227], v[56:59], v[24:27], v[224:227]
  v_mfma_f32_16x16x32_bf16 v[224:227], v[60:63], v[28:31], v[224:227]
  s_waitcnt lgkmcnt(3)
  v_mfma_f32_16x16x32_bf16 v[228:231], v[64:67], v[16:19], 0
  s_waitcnt lgkmcnt(2)
  v_mfma_f32_16x16x32_bf16 v[228:231], v[68:71], v[20:23], v[228:231]
  s_waitcnt lgkmcnt(1)
  v_mfma_f32_16x16x32_bf16 v[228:231], v[72:75], v[24:27], v[228:231]
  s_waitcnt lgkmcnt(0)
  v_mfma_f32_16x16x32_bf16 v[228:231], v[76:79], v[28:31], v[228:231]
  s_cmp_gt_i32 s50, 0
  s_cselect_b64 vcc, -1, 0
  s_subb_u32 s50, s50, 0
  s_waitcnt vmcnt(7)
  s_cbranch_vccnz L_go11
  s_waitcnt vmcnt(4)
L_go11:
  s_mov_b32 m0, s78
  s_nop 0
  buffer_load_dwordx4 v8, s[20:23], s55 offen offset:0 nt lds
  s_waitcnt vmcnt(7)
  s_cbranch_vccnz L_go12
  s_waitcnt vmcnt(4)
L_go12:
  buffer_load_dwordx4 v9, s[20:23], s55 offen offset:1024 nt lds
  s_waitcnt vmcnt(7)
  s_cbranch_vccnz L_go13
  s_waitcnt vmcnt(4)
L_go13:
  buffer_load_dwordx4 v10, s[20:23], s55 offen offset:2048 nt lds
  s_waitcnt vmcnt(7)
  s_cbranch_vccnz L_go14
  s_waitcnt vmcnt(4)
L_go14:
  buffer_load_dwordx4 v11, s[20:23], s55 offen offset:3072 nt lds
  s_add_u32 s55, s55, 32768
  ds_read_b128 v[48:51], v12 offset:8192
  ds_read_b128 v[52:55], v13 offset:8192
  ds_read_b128 v[56:59], v14 offset:8192
  ds_read_b128 v[60:63], v15 offset:8192
  s_waitcnt vmcnt(7)
  s_cbranch_vccnz L_go15
  s_waitcnt vmcnt(4)
L_go15:
  s_add_u32 m0, s78, 4096
  s_nop 0
  buffer_load_dwordx4 v8, s[20:23], s56 offen offset:0 nt lds
  s_waitcnt vmcnt(7)
  s_cbranch_vccnz L_go16
  s_waitcnt vmcnt(4)
L_go16:
  buffer_load_dwordx4 v9, s[20:23], s56 offen offset:1024 nt lds
  s_waitcnt vmcnt(7)
  s_cbranch_vccnz L_go17
  s_waitcnt vmcnt(4)
L_go17:
  buffer_load_dwordx4 v10, s[20:23], s56 offen offset:2048 nt lds
  s_waitcnt vmcnt(7)
  s_cbranch_vccnz L_go18
  s_waitcnt vmcnt(4)
L_go18:
  buffer_load_dwordx4 v11, s[20:23], s56 offen offset:3072 nt lds
  s_add_u32 s56, s56, 32768
  ds_read_b128 v[64:67], v12 offset:12288
  ds_read_b128 v[68:71], v13 offset:12288
  ds_read_b128 v[72:75], v14 offset:12288
  ds_read_b128 v[76:79], v15 offset:12288
  s_waitcnt lgkmcnt(4)
  v_mfma_f32_16x16x32_bf16 v[224:227], v[48:51], v[32:35], v[224:227]
  v_mfma_f32_16x16x32_bf16 v[224:227], v[52:55], v[36:39], v[224:227]
  v_mfma_f32_16x16x32_bf16 v[224:227], v[56:59], v[40:43], v[224:227]
  v_mfma_f32_16x16x32_bf16 v[224:227], v[60:63], v[44:47], v[224:227]
  s_waitcnt lgkmcnt(3)
  v_mfma_f32_16x16x32_bf16 v[228:231], v[64:67], v[32:35], v[228:231]
  s_waitcnt lgkmcnt(2)
  v_mfma_f32_16x16x32_bf16 v[228:231], v[68:71], v[36:39], v[228:231]
  s_waitcnt lgkmcnt(1)
  v_mfma_f32_16x16x32_bf16 v[228:231], v[72:75], v[40:43], v[228:231]
  s_waitcnt lgkmcnt(0)
  v_mfma_f32_16x16x32_bf16 v[228:231], v[76:79], v[44:47], v[228:231]
  s_barrier
  s_bitcmp1_b32 s59, 0
  s_cbranch_scc1 L_nb19
  ds_read_b32 v5, v1
  s_waitcnt lgkmcnt(0)
  v_readfirstlane_b32 s50, v5
L_nb19:
  s_cmp_gt_i32 s50, 0
  s_cselect_b64 vcc, -1, 0
  s_subb_u32 s50, s50, 0
  s_waitcnt vmcnt(7)
  s_cbranch_vccnz L_go20
  s_waitcnt vmcnt(4)
L_go20:
  s_add_u32 m0, s78, 8192
  s_nop 0
  buffer_load_dwordx4 v8, s[20:23], s55 offen offset:0 nt lds
  s_waitcnt vmcnt(7)
  s_cbranch_vccnz L_go21
  s_waitcnt vmcnt(4)
L_go21:
  buffer_load_dwordx4 v9, s[20:23], s55 offen offset:1024 nt lds
  v_cvt_pk_bf16_f32 v4, v224, v225
  v_cvt_pk_bf16_f32 v5, v226, v227
  v_lshlrev_b32 v224, 16, v4
  v_and_b32 v225, 0xffff0000, v4
  v_lshlrev_b32 v226, 16, v5
  s_waitcnt vmcnt(7)
  s_cbranch_vccnz L_go22
  s_waitcnt vmcnt(4)
L_go22:
  buffer_load_dwordx4 v10, s[20:23], s55 offen offset:2048 nt lds
  v_and_b32 v227, 0xffff0000, v5
  v_pk_mul_f32 v[224:225], v[224:225], s[98:99]
  v_pk_mul_f32 v[226:227], v[226:227], s[98:99]
  v_cvt_pk_bf16_f32 v4, v224, v225
  v_cvt_pk_bf16_f32 v5, v226, v227
  s_waitcnt vmcnt(7)
  s_cbranch_vccnz L_go23
  s_waitcnt vmcnt(4)
L_go23:
  buffer_load_dwordx4 v11, s[20:23], s55 offen offset:3072 nt lds
  s_add_u32 s55, s55, 32768
  ds_read_b128 v[48:51], v12 offset:0
  ds_read_b128 v[52:55], v13 offset:0
  ds_read_b128 v[56:59], v14 offset:0
  ds_read_b128 v[60:63], v15 offset:0
  v_lshlrev_b32 v224, 16, v4
  v_and_b32 v225, 0xffff0000, v4
  v_lshlrev_b32 v226, 16, v5
  v_and_b32 v227, 0xffff0000, v5
  v_cvt_pk_bf16_f32 v4, v228, v229
  s_waitcnt vmcnt(7)
  s_cbranch_vccnz L_go24
  s_waitcnt vmcnt(4)
L_go24:
  s_add_u32 m0, s78, 12288
  s_nop 0
  buffer_load_dwordx4 v8, s[20:23], s56 offen offset:0 nt lds
  v_cvt_pk_bf16_f32 v5, v230, v231
  v_lshlrev_b32 v228, 16, v4
  v_and_b32 v229, 0xffff0000, v4
  v_lshlrev_b32 v230, 16, v5
  v_and_b32 v231, 0xffff0000, v5
  s_waitcnt vmcnt(7)
  s_cbranch_vccnz L_go25
  s_waitcnt vmcnt(4)
L_go25:
  buffer_load_dwordx4 v9, s[20:23], s56 offen offset:1024 nt lds
  v_pk_mul_f32 v[228:229], v[228:229], s[98:99]
  v_pk_mul_f32 v[230:231], v[230:231], s[98:99]
  v_cvt_pk_bf16_f32 v4, v228, v229
  v_cvt_pk_bf16_f32 v5, v230, v231
  v_lshlrev_b32 v228, 16, v4
  s_waitcnt vmcnt(7)
  s_cbranch_vccnz L_go26
  s_waitcnt vmcnt(4)
L_go26:
  buffer_load_dwordx4 v10, s[20:23], s56 offen offset:2048 nt lds
  v_and_b32 v229, 0xffff0000, v4
  v_lshlrev_b32 v230, 16, v5
  v_and_b32 v231, 0xffff0000, v5
  v_max3_f32 v6, v6, v224, v225
  v_max3_f32 v6, v6, v226, v227
  s_waitcnt vmcnt(7)
  s_cbranch_vccnz L_go27
  s_waitcnt vmcnt(4)
L_go27:
  buffer_load_dwordx4 v11, s[20:23], s56 offen offset:3072 nt lds
  s_add_u32 s56, s56, 32768
  v_max3_f32 v6, v6, v228, v229
  v_max3_f32 v6, v6, v230, v231
  ds_read_b128 v[64:67], v12 offset:4096
  ds_read_b128 v[68:71], v13 offset:4096
  ds_read_b128 v[72:75], v14 offset:4096
  ds_read_b128 v[76:79], v15 offset:4096
  s_waitcnt lgkmcnt(4)
  v_mfma_f32_16x16x32_bf16 v[232:235], v[48:51], v[16:19], 0
  v_mfma_f32_16x16x32_bf16 v[232:235], v[52:55], v[20:23], v[232:235]
  v_mfma_f32_16x16x32_bf16 v[232:235], v[56:59], v[24:27], v[232:235]
  v_mfma_f32_16x16x32_bf16 v[232:235], v[60:63], v[28:31], v[232:235]
  s_waitcnt lgkmcnt(3)
  v_mfma_f32_16x16x32_bf16 v[236:239], v[64:67], v[16:19], 0
  s_waitcnt lgkmcnt(2)
  v_mfma_f32_16x16x32_bf16 v[236:239], v[68:71], v[20:23], v[236:239]
  s_waitcnt lgkmcnt(1)
  v_mfma_f32_16x16x32_bf16 v[236:239], v[72:75], v[24:27], v[236:239]
  s_waitcnt lgkmcnt(0)
  v_mfma_f32_16x16x32_bf16 v[236:239], v[76:79], v[28:31], v[236:239]
  s_cmp_gt_i32 s50, 0
  s_cselect_b64 vcc, -1, 0
  s_subb_u32 s50, s50, 0
  s_cmp_eq_u32 s59, 7
  s_cbranch_scc1 L_klast
  s_waitcnt vmcnt(7)
  s_cbranch_vccnz L_go29
  s_waitcnt vmcnt(4)
L_go29:
  s_mov_b32 m0, s78
  s_nop 0
  buffer_load_dwordx4 v8, s[20:23], s55 offen offset:0 nt lds
  s_waitcnt vmcnt(7)
  s_cbranch_vccnz L_go30
  s_waitcnt vmcnt(4)
L_go30:
  buffer_load_dwordx4 v9, s[20:23], s55 offen offset:1024 nt lds
  s_waitcnt vmcnt(7)
  s_cbranch_vccnz L_go31
  s_waitcnt vmcnt(4)
L_go31:
  buffer_load_dwordx4 v10, s[20:23], s55 offen offset:2048 nt lds
  s_waitcnt vmcnt(7)
  s_cbranch_vccnz L_go32
  s_waitcnt vmcnt(4)
L_go32:
  buffer_load_dwordx4 v11, s[20:23], s55 offen offset:3072 nt lds
  s_add_u32 s55, s55, 32768
  ds_read_b128 v[48:51], v12 offset:8192
  ds_read_b128 v[52:55], v13 offset:8192
  ds_read_b128 v[56:59], v14 offset:8192
  ds_read_b128 v[60:63], v15 offset:8192
  s_waitcnt vmcnt(7)
  s_cbranch_vccnz L_go33
  s_waitcnt vmcnt(4)
L_go33:
  s_add_u32 m0, s78, 4096
  s_nop 0
  buffer_load_dwordx4 v8, s[20:23], s56 offen offset:0 nt lds
  s_waitcnt vmcnt(7)
  s_cbranch_vccnz L_go34
  s_waitcnt vmcnt(4)
L_go34:
  buffer_load_dwordx4 v9, s[20:23], s56 offen offset:1024 nt lds
  s_waitcnt vmcnt(7)
  s_cbranch_vccnz L_go35
  s_waitcnt vmcnt(4)
L_go35:
  buffer_load_dwordx4 v10, s[20:23], s56 offen offset:2048 nt lds
  s_waitcnt vmcnt(7)
  s_cbranch_vccnz L_go36
  s_waitcnt vmcnt(4)
L_go36:
  buffer_load_dwordx4 v11, s[20:23], s56 offen offset:3072 nt lds
  s_add_u32 s56, s56, 32768
  ds_read_b128 v[64:67], v12 offset:12288
  ds_read_b128 v[68:71], v13 offset:12288
  ds_read_b128 v[72:75], v14 offset:12288
  ds_read_b128 v[76:79], v15 offset:12288
  s_waitcnt lgkmcnt(4)
  v_mfma_f32_16x16x32_bf16 v[232:235], v[48:51], v[32:35], v[232:235]
  v_mfma_f32_16x16x32_bf16 v[232:235], v[52:55], v[36:39], v[232:235]
  v_mfma_f32_16x16x32_bf16 v[232:235], v[56:59], v[40:43], v[232:235]
  v_mfma_f32_16x16x32_bf16 v[232:235], v[60:63], v[44:47], v[232:235]
  s_waitcnt lgkmcnt(3)
  v_mfma_f32_16x16x32_bf16 v[236:239], v[64:67], v[32:35], v[236:239]
  s_waitcnt lgkmcnt(2)
  v_mfma_f32_16x16x32_bf16 v[236:239], v[68:71], v[36:39], v[236:239]
  s_waitcnt lgkmcnt(1)
  v_mfma_f32_16x16x32_bf16 v[236:239], v[72:75], v[40:43], v[236:239]
  s_waitcnt lgkmcnt(0)
  v_mfma_f32_16x16x32_bf16 v[236:239], v[76:79], v[44:47], v[236:239]
  s_add_u32 s59, s59, 1
  s_branch L_ktop
L_klast:
  s_waitcnt vmcnt(7)
  s_cbranch_vccnz L_go37
  s_waitcnt vmcnt(4)
L_go37:
  buffer_load_dwordx4 v[80:83], v0, s[24:27], s57 offen offset:0 nt
  s_waitcnt vmcnt(7)
  s_cbranch_vccnz L_go38
  s_waitcnt vmcnt(4)
L_go38:
  buffer_load_dwordx4 v[84:87], v0, s[24:27], s57 offen offset:1024 nt
  s_waitcnt vmcnt(7)
  s_cbranch_vccnz L_go39
  s_waitcnt vmcnt(4)
L_go39:
  buffer_load_dwordx4 v[88:91], v0, s[24:27], s57 offen offset:2048 nt
  s_waitcnt vmcnt(7)
  s_cbranch_vccnz L_go40
  s_waitcnt vmcnt(4)
L_go40:
  buffer_load_dwordx4 v[92:95], v0, s[24:27], s57 offen offset:3072 nt
  s_add_u32 s57, s57, 32768
  ds_read_b128 v[48:51], v12 offset:8192
  ds_read_b128 v[52:55], v13 offset:8192
  ds_read_b128 v[56:59], v14 offset:8192
  ds_read_b128 v[60:63], v15 offset:8192
  s_waitcnt vmcnt(7)
  s_cbranch_vccnz L_go41
  s_waitcnt vmcnt(4)
L_go41:
  buffer_load_dwordx4 v[96:99], v0, s[24:27], s58 offen offset:0 nt
  s_waitcnt vmcnt(7)
  s_cbranch_vccnz L_go42
  s_waitcnt vmcnt(4)
L_go42:
  buffer_load_dwordx4 v[100:103], v0, s[24:27], s58 offen offset:1024 nt
  s_waitcnt vmcnt(7)
  s_cbranch_vccnz L_go43
  s_waitcnt vmcnt(4)
L_go43:
  buffer_load_dwordx4 v[104:107], v0, s[24:27], s58 offen offset:2048 nt
  s_waitcnt vmcnt(7)
  s_cbranch_vccnz L_go44
  s_waitcnt vmcnt(4)
L_go44:
  buffer_load_dwordx4 v[108:111], v0, s[24:27], s58 offen offset:3072 nt
  s_add_u32 s58, s58, 32768
  ds_read_b128 v[64:67], v12 offset:12288
  ds_read_b128 v[68:71], v13 offset:12288
  ds_read_b128 v[72:75], v14 offset:12288
  ds_read_b128 v[76:79], v15 offset:12288
  s_waitcnt lgkmcnt(4)
  v_mfma_f32_16x16x32_bf16 v[232:235], v[48:51], v[32:35], v[232:235]
  v_mfma_f32_16x16x32_bf16 v[232:235], v[52:55], v[36:39], v[232:235]
  v_mfma_f32_16x16x32_bf16 v[232:235], v[56:59], v[40:43], v[232:235]
  v_mfma_f32_16x16x32_bf16 v[232:235], v[60:63], v[44:47], v[232:235]
  s_waitcnt lgkmcnt(3)
  v_mfma_f32_16x16x32_bf16 v[236:239], v[64:67], v[32:35], v[236:239]
  s_waitcnt lgkmcnt(2)
  v_mfma_f32_16x16x32_bf16 v[236:239], v[68:71], v[36:39], v[236:239]
  s_waitcnt lgkmcnt(1)
  v_mfma_f32_16x16x32_bf16 v[236:239], v[72:75], v[40:43], v[236:239]
  s_waitcnt lgkmcnt(0)
  v_mfma_f32_16x16x32_bf16 v[236:239], v[76:79], v[44:47], v[236:239]
  s_barrier
  s_waitcnt vmcnt(4)
  buffer_load_dwordx4 v[48:51], v0, s[24:27], s57 offen offset:0 nt
  v_perm_b32 v16, v84, v80, s64
  v_perm_b32 v20, v84, v80, s65
  v_perm_b32 v24, v85, v81, s64
  v_perm_b32 v28, v85, v81, s65
  v_perm_b32 v32, v86, v82, s64
  v_perm_b32 v36, v86, v82, s65
  v_perm_b32 v40, v87, v83, s64
  v_perm_b32 v44, v87, v83, s65
  v_perm_b32 v17, v92, v88, s64
  v_perm_b32 v21, v92, v88, s65
  v_perm_b32 v25, v93, v89, s64
  v_perm_b32 v29, v93, v89, s65
  v_perm_b32 v33, v94, v90, s64
  v_perm_b32 v37, v94, v90, s65
  v_perm_b32 v41, v95, v91, s64
  v_perm_b32 v45, v95, v91, s65
  s_nop 6
  v_cvt_pk_bf16_f32 v4, v232, v233
  v_cvt_pk_bf16_f32 v5, v234, v235
  v_lshlrev_b32 v232, 16, v4
  v_and_b32 v233, 0xffff0000, v4
  v_lshlrev_b32 v234, 16, v5
  v_and_b32 v235, 0xffff0000, v5
  v_pk_mul_f32 v[232:233], v[232:233], s[98:99]
  v_pk_mul_f32 v[234:235], v[234:235], s[98:99]
  v_cvt_pk_bf16_f32 v4, v232, v233
  v_cvt_pk_bf16_f32 v5, v234, v235
  v_lshlrev_b32 v232, 16, v4
  v_and_b32 v233, 0xffff0000, v4
  v_lshlrev_b32 v234, 16, v5
  v_and_b32 v235, 0xffff0000, v5
  v_cvt_pk_bf16_f32 v4, v236, v237
  v_cvt_pk_bf16_f32 v5, v238, v239
  v_lshlrev_b32 v236, 16, v4
  v_and_b32 v237, 0xffff0000, v4
  v_lshlrev_b32 v238, 16, v5
  v_and_b32 v239, 0xffff0000, v5
  v_pk_mul_f32 v[236:237], v[236:237], s[98:99]
  v_pk_mul_f32 v[238:239], v[238:239], s[98:99]
  v_cvt_pk_bf16_f32 v4, v236, v237
  v_cvt_pk_bf16_f32 v5, v238, v239
  v_lshlrev_b32 v236, 16, v4
  v_and_b32 v237, 0xffff0000, v4
  v_lshlrev_b32 v238, 16, v5
  v_and_b32 v239, 0xffff0000, v5
  v_max3_f32 v6, v6, v232, v233
  v_max3_f32 v6, v6, v234, v235
  v_max3_f32 v6, v6, v236, v237
  v_max3_f32 v6, v6, v238, v239
  v_mov_b32 v5, v6
  s_nop 1
  v_permlane16_swap_b32 v6, v5
  v_max_f32 v6, v6, v5
  v_mov_b32 v5, v6
  s_nop 1
  v_permlane32_swap_b32 v6, v5
  v_max_f32 v6, v6, v5
  s_nop 1
  v_max_f32_dpp v6, v6, v6 row_ror:8 row_mask:0xf bank_mask:0xf
  v_mul_f32 v3, s63, v6
  v_fma_f32 v112, v112, s62, v3
  v_fma_f32 v113, v113, s62, v3
  v_fma_f32 v114, v114, s62, v3
  v_fma_f32 v115, v115, s62, v3
  s_waitcnt vmcnt(4)
  buffer_load_dwordx4 v[52:55], v0, s[24:27], s57 offen offset:1024 nt
  v_fma_f32 v116, v116, s62, v3
  v_fma_f32 v117, v117, s62, v3
  v_fma_f32 v118, v118, s62, v3
  v_fma_f32 v119, v119, s62, v3
  v_exp_f32 v112, v112
  v_exp_f32 v113, v113
  v_exp_f32 v114, v114
  v_exp_f32 v115, v115
  v_exp_f32 v116, v116
  v_exp_f32 v117, v117
  v_exp_f32 v118, v118
  v_exp_f32 v119, v119
  v_fma_f32 v120, v120, s62, v3
  v_fma_f32 v121, v121, s62, v3
  v_fma_f32 v122, v122, s62, v3
  v_fma_f32 v123, v123, s62, v3
  v_fma_f32 v124, v124, s62, v3
  v_fma_f32 v125, v125, s62, v3
  v_fma_f32 v126, v126, s62, v3
  v_fma_f32 v127, v127, s62, v3
  v_exp_f32 v120, v120
  v_exp_f32 v121, v121
  v_exp_f32 v122, v122
  v_exp_f32 v123, v123
  v_exp_f32 v124, v124
  v_exp_f32 v125, v125
  v_exp_f32 v126, v126
  v_exp_f32 v127, v127
  v_mov_b64 v[4:5], v[112:113]
  v_pk_add_f32 v[4:5], v[4:5], v[114:115]
  v_pk_add_f32 v[4:5], v[4:5], v[116:117]
  v_pk_add_f32 v[4:5], v[4:5], v[118:119]
  v_fma_f32 v128, v128, s62, v3
  v_fma_f32 v129, v129, s62, v3
  v_fma_f32 v130, v130, s62, v3
  v_fma_f32 v131, v131, s62, v3
  v_fma_f32 v132, v132, s62, v3
  v_fma_f32 v133, v133, s62, v3
  v_fma_f32 v134, v134, s62, v3
  v_fma_f32 v135, v135, s62, v3
  v_exp_f32 v128, v128
  v_exp_f32 v129, v129
  v_exp_f32 v130, v130
  s_waitcnt vmcnt(4)
  buffer_load_dwordx4 v[56:59], v0, s[24:27], s57 offen offset:2048 nt
  v_perm_b32 v18, v100, v96, s64
  v_perm_b32 v22, v100, v96, s65
  v_perm_b32 v26, v101, v97, s64
  v_perm_b32 v30, v101, v97, s65
  v_perm_b32 v34, v102, v98, s64
  v_perm_b32 v38, v102, v98, s65
  v_perm_b32 v42, v103, v99, s64
  v_perm_b32 v46, v103, v99, s65
  v_exp_f32 v131, v131
  v_exp_f32 v132, v132
  v_exp_f32 v133, v133
  v_exp_f32 v134, v134
  v_exp_f32 v135, v135
  v_pk_add_f32 v[4:5], v[4:5], v[120:121]
  v_pk_add_f32 v[4:5], v[4:5], v[122:123]
  v_pk_add_f32 v[4:5], v[4:5], v[124:125]
  v_pk_add_f32 v[4:5], v[4:5], v[126:127]
  v_fma_f32 v136, v136, s62, v3
  v_fma_f32 v137, v137, s62, v3
  v_fma_f32 v138, v138, s62, v3
  v_fma_f32 v139, v139, s62, v3
  v_fma_f32 v140, v140, s62, v3
  v_fma_f32 v141, v141, s62, v3
  v_fma_f32 v142, v142, s62, v3
  v_fma_f32 v143, v143, s62, v3
  v_exp_f32 v136, v136
  v_exp_f32 v137, v137
  v_exp_f32 v138, v138
  v_exp_f32 v139, v139
  v_exp_f32 v140, v140
  v_exp_f32 v141, v141
  v_exp_f32 v142, v142
  v_exp_f32 v143, v143
  v_pk_add_f32 v[4:5], v[4:5], v[128:129]
  v_pk_add_f32 v[4:5], v[4:5], v[130:131]
  v_pk_add_f32 v[4:5], v[4:5], v[132:133]
  v_pk_add_f32 v[4:5], v[4:5], v[134:135]
  v_fma_f32 v144, v144, s62, v3
  v_fma_f32 v145, v145, s62, v3
  v_fma_f32 v146, v146, s62, v3
  v_fma_f32 v147, v147, s62, v3
  v_fma_f32 v148, v148, s62, v3
  v_fma_f32 v149, v149, s62, v3
  v_fma_f32 v150, v150, s62, v3
  v_fma_f32 v151, v151, s62, v3
  v_exp_f32 v144, v144
  v_exp_f32 v145, v145
  v_exp_f32 v146, v146
  v_exp_f32 v147, v147
  s_waitcnt vmcnt(4)
  buffer_load_dwordx4 v[60:63], v0, s[24:27], s57 offen offset:3072 nt
  s_add_u32 s57, s57, 32768
  v_exp_f32 v148, v148
  v_exp_f32 v149, v149
  v_exp_f32 v150, v150
  v_exp_f32 v151, v151
  v_pk_add_f32 v[4:5], v[4:5], v[136:137]
  v_pk_add_f32 v[4:5], v[4:5], v[138:139]
  v_pk_add_f32 v[4:5], v[4:5], v[140:141]
  v_pk_add_f32 v[4:5], v[4:5], v[142:143]
  v_fma_f32 v152, v152, s62, v3
  v_fma_f32 v153, v153, s62, v3
  v_fma_f32 v154, v154, s62, v3
  v_fma_f32 v155, v155, s62, v3
  v_fma_f32 v156, v156, s62, v3
  v_fma_f32 v157, v157, s62, v3
  v_fma_f32 v158, v158, s62, v3
  v_fma_f32 v159, v159, s62, v3
  v_exp_f32 v152, v152
  v_exp_f32 v153, v153
  v_exp_f32 v154, v154
  v_exp_f32 v155, v155
  v_exp_f32 v156, v156
  v_exp_f32 v157, v157
  v_exp_f32 v158, v158
  v_exp_f32 v159, v159
  v_pk_add_f32 v[4:5], v[4:5], v[144:145]
  v_pk_add_f32 v[4:5], v[4:5], v[146:147]
  v_pk_add_f32 v[4:5], v[4:5], v[148:149]
  v_pk_add_f32 v[4:5], v[4:5], v[150:151]
  v_fma_f32 v160, v160, s62, v3
  v_fma_f32 v161, v161, s62, v3
  v_fma_f32 v162, v162, s62, v3
  v_fma_f32 v163, v163, s62, v3
  v_fma_f32 v164, v164, s62, v3
  v_fma_f32 v165, v165, s62, v3
  v_fma_f32 v166, v166, s62, v3
  v_fma_f32 v167, v167, s62, v3
  v_exp_f32 v160, v160
  v_exp_f32 v161, v161
  v_exp_f32 v162, v162
  v_exp_f32 v163, v163
  v_exp_f32 v164, v164
  s_waitcnt vmcnt(4)
  buffer_load_dwordx4 v[64:67], v0, s[24:27], s58 offen offset:0 nt
  v_perm_b32 v19, v108, v104, s64
  v_perm_b32 v23, v108, v104, s65
  v_perm_b32 v27, v109, v105, s64
  v_perm_b32 v31, v109, v105, s65
  v_perm_b32 v35, v110, v106, s64
  v_perm_b32 v39, v110, v106, s65
  v_perm_b32 v43, v111, v107, s64
  v_perm_b32 v47, v111, v107, s65
  v_exp_f32 v165, v165
  v_exp_f32 v166, v166
  v_exp_f32 v167, v167
  v_pk_add_f32 v[4:5], v[4:5], v[152:153]
  v_pk_add_f32 v[4:5], v[4:5], v[154:155]
  v_pk_add_f32 v[4:5], v[4:5], v[156:157]
  v_pk_add_f32 v[4:5], v[4:5], v[158:159]
  v_fma_f32 v168, v168, s62, v3
  v_fma_f32 v169, v169, s62, v3
  v_fma_f32 v170, v170, s62, v3
  v_fma_f32 v171, v171, s62, v3
  v_fma_f32 v172, v172, s62, v3
  v_fma_f32 v173, v173, s62, v3
  v_fma_f32 v174, v174, s62, v3
  v_fma_f32 v175, v175, s62, v3
  v_exp_f32 v168, v168
  v_exp_f32 v169, v169
  v_exp_f32 v170, v170
  v_exp_f32 v171, v171
  v_exp_f32 v172, v172
  v_exp_f32 v173, v173
  v_exp_f32 v174, v174
  v_exp_f32 v175, v175
  v_pk_add_f32 v[4:5], v[4:5], v[160:161]
  v_pk_add_f32 v[4:5], v[4:5], v[162:163]
  v_pk_add_f32 v[4:5], v[4:5], v[164:165]
  v_pk_add_f32 v[4:5], v[4:5], v[166:167]
  v_fma_f32 v176, v176, s62, v3
  v_fma_f32 v177, v177, s62, v3
  v_fma_f32 v178, v178, s62, v3
  v_fma_f32 v179, v179, s62, v3
  v_fma_f32 v180, v180, s62, v3
  v_fma_f32 v181, v181, s62, v3
  v_fma_f32 v182, v182, s62, v3
  v_fma_f32 v183, v183, s62, v3
  v_exp_f32 v176, v176
  v_exp_f32 v177, v177
  v_exp_f32 v178, v178
  v_exp_f32 v179, v179
  v_exp_f32 v180, v180
  v_exp_f32 v181, v181
  s_waitcnt vmcnt(4)
  buffer_load_dwordx4 v[68:71], v0, s[24:27], s58 offen offset:1024 nt
  v_exp_f32 v182, v182
  v_exp_f32 v183, v183
  v_pk_add_f32 v[4:5], v[4:5], v[168:169]
  v_pk_add_f32 v[4:5], v[4:5], v[170:171]
  v_pk_add_f32 v[4:5], v[4:5], v[172:173]
  v_pk_add_f32 v[4:5], v[4:5], v[174:175]
  v_fma_f32 v184, v184, s62, v3
  v_fma_f32 v185, v185, s62, v3
  v_fma_f32 v186, v186, s62, v3
  v_fma_f32 v187, v187, s62, v3
  v_fma_f32 v188, v188, s62, v3
  v_fma_f32 v189, v189, s62, v3
  v_fma_f32 v190, v190, s62, v3
  v_fma_f32 v191, v191, s62, v3
  v_exp_f32 v184, v184
  v_exp_f32 v185, v185
  v_exp_f32 v186, v186
  v_exp_f32 v187, v187
  v_exp_f32 v188, v188
  v_exp_f32 v189, v189
  v_exp_f32 v190, v190
  v_exp_f32 v191, v191
  v_pk_add_f32 v[4:5], v[4:5], v[176:177]
  v_pk_add_f32 v[4:5], v[4:5], v[178:179]
  v_pk_add_f32 v[4:5], v[4:5], v[180:181]
  v_pk_add_f32 v[4:5], v[4:5], v[182:183]
  v_fma_f32 v192, v192, s62, v3
  v_fma_f32 v193, v193, s62, v3
  v_fma_f32 v194, v194, s62, v3
  v_fma_f32 v195, v195, s62, v3
  v_fma_f32 v196, v196, s62, v3
  v_fma_f32 v197, v197, s62, v3
  v_fma_f32 v198, v198, s62, v3
  v_fma_f32 v199, v199, s62, v3
  v_exp_f32 v192, v192
  v_exp_f32 v193, v193
  v_exp_f32 v194, v194
  v_exp_f32 v195, v195
  v_exp_f32 v196, v196
  v_exp_f32 v197, v197
  v_exp_f32 v198, v198
  s_waitcnt vmcnt(4)
  buffer_load_dwordx4 v[72:75], v0, s[24:27], s58 offen offset:2048 nt
  v_exp_f32 v199, v199
  v_pk_add_f32 v[4:5], v[4:5], v[184:185]
  v_pk_add_f32 v[4:5], v[4:5], v[186:187]
  v_pk_add_f32 v[4:5], v[4:5], v[188:189]
  v_pk_add_f32 v[4:5], v[4:5], v[190:191]
  v_fma_f32 v200, v200, s62, v3
  v_fma_f32 v201, v201, s62, v3
  v_fma_f32 v202, v202, s62, v3
  v_fma_f32 v203, v203, s62, v3
  v_fma_f32 v204, v204, s62, v3
  v_fma_f32 v205, v205, s62, v3
  v_fma_f32 v206, v206, s62, v3
  v_fma_f32 v207, v207, s62, v3
  v_exp_f32 v200, v200
  v_exp_f32 v201, v201
  v_exp_f32 v202, v202
  v_exp_f32 v203, v203
  v_exp_f32 v204, v204
  v_exp_f32 v205, v205
  v_exp_f32 v206, v206
  v_exp_f32 v207, v207
  v_pk_add_f32 v[4:5], v[4:5], v[192:193]
  v_pk_add_f32 v[4:5], v[4:5], v[194:195]
  v_pk_add_f32 v[4:5], v[4:5], v[196:197]
  v_pk_add_f32 v[4:5], v[4:5], v[198:199]
  v_fma_f32 v208, v208, s62, v3
  v_fma_f32 v209, v209, s62, v3
  v_fma_f32 v210, v210, s62, v3
  v_fma_f32 v211, v211, s62, v3
  v_fma_f32 v212, v212, s62, v3
  v_fma_f32 v213, v213, s62, v3
  v_fma_f32 v214, v214, s62, v3
  v_fma_f32 v215, v215, s62, v3
  v_exp_f32 v208, v208
  v_exp_f32 v209, v209
  v_exp_f32 v210, v210
  v_exp_f32 v211, v211
  v_exp_f32 v212, v212
  v_exp_f32 v213, v213
  v_exp_f32 v214, v214
  v_exp_f32 v215, v215
  s_waitcnt vmcnt(4)
  buffer_load_dwordx4 v[76:79], v0, s[24:27], s58 offen offset:3072 nt
  s_add_u32 s58, s58, 32768
  v_pk_add_f32 v[4:5], v[4:5], v[200:201]
  v_pk_add_f32 v[4:5], v[4:5], v[202:203]
  v_pk_add_f32 v[4:5], v[4:5], v[204:205]
  v_pk_add_f32 v[4:5], v[4:5], v[206:207]
  v_fma_f32 v216, v216, s62, v3
  v_fma_f32 v217, v217, s62, v3
  v_fma_f32 v218, v218, s62, v3
  v_fma_f32 v219, v219, s62, v3
  v_fma_f32 v220, v220, s62, v3
  v_fma_f32 v221, v221, s62, v3
  v_fma_f32 v222, v222, s62, v3
  v_fma_f32 v223, v223, s62, v3
  v_exp_f32 v216, v216
  v_exp_f32 v217, v217
  v_exp_f32 v218, v218
  v_exp_f32 v219, v219
  v_exp_f32 v220, v220
  v_exp_f32 v221, v221
  v_exp_f32 v222, v222
  v_exp_f32 v223, v223
  v_pk_add_f32 v[4:5], v[4:5], v[208:209]
  v_pk_add_f32 v[4:5], v[4:5], v[210:211]
  v_pk_add_f32 v[4:5], v[4:5], v[212:213]
  v_pk_add_f32 v[4:5], v[4:5], v[214:215]
  v_fma_f32 v224, v224, s62, v3
  v_fma_f32 v225, v225, s62, v3
  v_fma_f32 v226, v226, s62, v3
  v_fma_f32 v227, v227, s62, v3
  v_fma_f32 v228, v228, s62, v3
  v_fma_f32 v229, v229, s62, v3
  v_fma_f32 v230, v230, s62, v3
  v_fma_f32 v231, v231, s62, v3
  v_exp_f32 v224, v224
  v_exp_f32 v225, v225
  v_exp_f32 v226, v226
  v_exp_f32 v227, v227
  v_exp_f32 v228, v228
  v_exp_f32 v229, v229
  v_exp_f32 v230, v230
  v_exp_f32 v231, v231
  v_pk_add_f32 v[4:5], v[4:5], v[216:217]
  s_waitcnt vmcnt(4)
  buffer_load_dwordx4 v[80:83], v0, s[24:27], s57 offen offset:0 nt
  v_pk_add_f32 v[4:5], v[4:5], v[218:219]
  v_pk_add_f32 v[4:5], v[4:5], v[220:221]
  v_pk_add_f32 v[4:5], v[4:5], v[222:223]
  v_fma_f32 v232, v232, s62, v3
  v_fma_f32 v233, v233, s62, v3
  v_fma_f32 v234, v234, s62, v3
  v_fma_f32 v235, v235, s62, v3
  v_fma_f32 v236, v236, s62, v3
  v_fma_f32 v237, v237, s62, v3
  v_fma_f32 v238, v238, s62, v3
  v_fma_f32 v239, v239, s62, v3
  v_exp_f32 v232, v232
  v_exp_f32 v233, v233
  v_exp_f32 v234, v234
  v_exp_f32 v235, v235
  v_exp_f32 v236, v236
  v_exp_f32 v237, v237
  v_exp_f32 v238, v238
  v_exp_f32 v239, v239
  v_pk_add_f32 v[4:5], v[4:5], v[224:225]
  v_pk_add_f32 v[4:5], v[4:5], v[226:227]
  v_pk_add_f32 v[4:5], v[4:5], v[228:229]
  v_pk_add_f32 v[4:5], v[4:5], v[230:231]
  v_pk_add_f32 v[4:5], v[4:5], v[232:233]
  v_pk_add_f32 v[4:5], v[4:5], v[234:235]
  v_pk_add_f32 v[4:5], v[4:5], v[236:237]
  v_pk_add_f32 v[4:5], v[4:5], v[238:239]
  v_add_f32 v7, v4, v5
  v_mov_b32 v5, v7
  s_nop 1
  v_permlane16_swap_b32 v7, v5
  v_add_f32 v7, v7, v5
  v_mov_b32 v5, v7
  s_nop 1
  v_permlane32_swap_b32 v7, v5
  v_add_f32 v7, v7, v5
  s_nop 1
  v_add_f32_dpp v7, v7, v7 row_ror:8 row_mask:0xf bank_mask:0xf
  ds_write_b64 v241, v[6:7]
  v_and_b32 v5, 0xffffffe7, v241
  s_waitcnt lgkmcnt(0)
  s_waitcnt vmcnt(4)
  buffer_load_dwordx4 v[84:87], v0, s[24:27], s57 offen offset:1024 nt
  s_barrier
  ds_read_b128 v[248:251], v5
  ds_read_b128 v[252:255], v5 offset:16
  s_waitcnt lgkmcnt(0)
  v_max3_f32 v5, v248, v250, v252
  v_max_f32 v5, v5, v254
  v_sub_f32 v248, v248, v5
  v_sub_f32 v250, v250, v5
  v_sub_f32 v252, v252, v5
  v_sub_f32 v254, v254, v5
  v_sub_f32 v4, v6, v5
  v_mul_f32 v248, s62, v248
  v_mul_f32 v250, s62, v250
  v_mul_f32 v252, s62, v252
  v_mul_f32 v254, s62, v254
  v_mul_f32 v4, s62, v4
  v_exp_f32 v248, v248
  v_exp_f32 v250, v250
  v_exp_f32 v252, v252
  v_exp_f32 v254, v254
  v_exp_f32 v4, v4
  v_mul_f32 v5, v248, v249
  v_fmac_f32 v5, v250, v251
  v_fmac_f32 v5, v252, v253
  v_fmac_f32 v5, v254, v255
  v_rcp_f32 v5, v5
  s_nop 0
  v_mul_f32 v4, v4, v5
  v_pk_mul_f32 v[112:113], v[112:113], v[4:5] op_sel_hi:[1,0]
  v_pk_mul_f32 v[114:115], v[114:115], v[4:5] op_sel_hi:[1,0]
  v_pk_mul_f32 v[116:117], v[116:117], v[4:5] op_sel_hi:[1,0]
  v_pk_mul_f32 v[118:119], v[118:119], v[4:5] op_sel_hi:[1,0]
  v_cvt_pk_bf16_f32 v112, v112, v113
  v_cvt_pk_bf16_f32 v113, v114, v115
  v_cvt_pk_bf16_f32 v114, v116, v117
  v_cvt_pk_bf16_f32 v115, v118, v119
  v_pk_mul_f32 v[120:121], v[120:121], v[4:5] op_sel_hi:[1,0]
  v_pk_mul_f32 v[122:123], v[122:123], v[4:5] op_sel_hi:[1,0]
  v_pk_mul_f32 v[124:125], v[124:125], v[4:5] op_sel_hi:[1,0]
  v_pk_mul_f32 v[126:127], v[126:127], v[4:5] op_sel_hi:[1,0]
  s_waitcnt vmcnt(4)
  buffer_load_dwordx4 v[88:91], v0, s[24:27], s57 offen offset:2048 nt
  v_cvt_pk_bf16_f32 v116, v120, v121
  v_cvt_pk_bf16_f32 v117, v122, v123
  v_cvt_pk_bf16_f32 v118, v124, v125
  v_cvt_pk_bf16_f32 v119, v126, v127
  v_pk_mul_f32 v[128:129], v[128:129], v[4:5] op_sel_hi:[1,0]
  v_pk_mul_f32 v[130:131], v[130:131], v[4:5] op_sel_hi:[1,0]
  v_pk_mul_f32 v[132:133], v[132:133], v[4:5] op_sel_hi:[1,0]
  v_pk_mul_f32 v[134:135], v[134:135], v[4:5] op_sel_hi:[1,0]
  v_cvt_pk_bf16_f32 v120, v128, v129
  v_cvt_pk_bf16_f32 v121, v130, v131
  v_cvt_pk_bf16_f32 v122, v132, v133
  v_cvt_pk_bf16_f32 v123, v134, v135
  v_pk_mul_f32 v[136:137], v[136:137], v[4:5] op_sel_hi:[1,0]
  v_pk_mul_f32 v[138:139], v[138:139], v[4:5] op_sel_hi:[1,0]
  v_pk_mul_f32 v[140:141], v[140:141], v[4:5] op_sel_hi:[1,0]
  v_pk_mul_f32 v[142:143], v[142:143], v[4:5] op_sel_hi:[1,0]
  v_cvt_pk_bf16_f32 v124, v136, v137
  v_cvt_pk_bf16_f32 v125, v138, v139
  v_cvt_pk_bf16_f32 v126, v140, v141
  v_cvt_pk_bf16_f32 v127, v142, v143
  v_pk_mul_f32 v[144:145], v[144:145], v[4:5] op_sel_hi:[1,0]
  v_pk_mul_f32 v[146:147], v[146:147], v[4:5] op_sel_hi:[1,0]
  v_pk_mul_f32 v[148:149], v[148:149], v[4:5] op_sel_hi:[1,0]
  v_pk_mul_f32 v[150:151], v[150:151], v[4:5] op_sel_hi:[1,0]
  v_cvt_pk_bf16_f32 v128, v144, v145
  v_cvt_pk_bf16_f32 v129, v146, v147
  v_cvt_pk_bf16_f32 v130, v148, v149
  v_cvt_pk_bf16_f32 v131, v150, v151
  v_pk_mul_f32 v[152:153], v[152:153], v[4:5] op_sel_hi:[1,0]
  v_pk_mul_f32 v[154:155], v[154:155], v[4:5] op_sel_hi:[1,0]
  v_pk_mul_f32 v[156:157], v[156:157], v[4:5] op_sel_hi:[1,0]
  v_pk_mul_f32 v[158:159], v[158:159], v[4:5] op_sel_hi:[1,0]
  v_cvt_pk_bf16_f32 v132, v152, v153
  v_cvt_pk_bf16_f32 v133, v154, v155
  v_cvt_pk_bf16_f32 v134, v156, v157
  v_cvt_pk_bf16_f32 v135, v158, v159
  v_pk_mul_f32 v[160:161], v[160:161], v[4:5] op_sel_hi:[1,0]
  v_pk_mul_f32 v[162:163], v[162:163], v[4:5] op_sel_hi:[1,0]
  v_pk_mul_f32 v[164:165], v[164:165], v[4:5] op_sel_hi:[1,0]
  v_pk_mul_f32 v[166:167], v[166:167], v[4:5] op_sel_hi:[1,0]
  v_cvt_pk_bf16_f32 v136, v160, v161
  v_cvt_pk_bf16_f32 v137, v162, v163
  v_cvt_pk_bf16_f32 v138, v164, v165
  v_cvt_pk_bf16_f32 v139, v166, v167
  s_waitcnt vmcnt(4)
  buffer_load_dwordx4 v[92:95], v0, s[24:27], s57 offen offset:3072 nt
  s_add_u32 s57, s57, 32768
  v_pk_mul_f32 v[168:169], v[168:169], v[4:5] op_sel_hi:[1,0]
  v_pk_mul_f32 v[170:171], v[170:171], v[4:5] op_sel_hi:[1,0]
  v_pk_mul_f32 v[172:173], v[172:173], v[4:5] op_sel_hi:[1,0]
  v_pk_mul_f32 v[174:175], v[174:175], v[4:5] op_sel_hi:[1,0]
  v_cvt_pk_bf16_f32 v140, v168, v169
  v_cvt_pk_bf16_f32 v141, v170, v171
  v_cvt_pk_bf16_f32 v142, v172, v173
  v_cvt_pk_bf16_f32 v143, v174, v175
  v_pk_mul_f32 v[176:177], v[176:177], v[4:5] op_sel_hi:[1,0]
  v_pk_mul_f32 v[178:179], v[178:179], v[4:5] op_sel_hi:[1,0]
  v_pk_mul_f32 v[180:181], v[180:181], v[4:5] op_sel_hi:[1,0]
  v_pk_mul_f32 v[182:183], v[182:183], v[4:5] op_sel_hi:[1,0]
  v_cvt_pk_bf16_f32 v144, v176, v177
  v_cvt_pk_bf16_f32 v145, v178, v179
  v_cvt_pk_bf16_f32 v146, v180, v181
  v_cvt_pk_bf16_f32 v147, v182, v183
  v_pk_mul_f32 v[184:185], v[184:185], v[4:5] op_sel_hi:[1,0]
  v_pk_mul_f32 v[186:187], v[186:187], v[4:5] op_sel_hi:[1,0]
  v_pk_mul_f32 v[188:189], v[188:189], v[4:5] op_sel_hi:[1,0]
  v_pk_mul_f32 v[190:191], v[190:191], v[4:5] op_sel_hi:[1,0]
  v_cvt_pk_bf16_f32 v148, v184, v185
  v_cvt_pk_bf16_f32 v149, v186, v187
  v_cvt_pk_bf16_f32 v150, v188, v189
  v_cvt_pk_bf16_f32 v151, v190, v191
  v_pk_mul_f32 v[192:193], v[192:193], v[4:5] op_sel_hi:[1,0]
  v_pk_mul_f32 v[194:195], v[194:195], v[4:5] op_sel_hi:[1,0]
  v_pk_mul_f32 v[196:197], v[196:197], v[4:5] op_sel_hi:[1,0]
  v_pk_mul_f32 v[198:199], v[198:199], v[4:5] op_sel_hi:[1,0]
  v_cvt_pk_bf16_f32 v152, v192, v193
  v_cvt_pk_bf16_f32 v153, v194, v195
  v_cvt_pk_bf16_f32 v154, v196, v197
  v_cvt_pk_bf16_f32 v155, v198, v199
  v_pk_mul_f32 v[200:201], v[200:201], v[4:5] op_sel_hi:[1,0]
  v_pk_mul_f32 v[202:203], v[202:203], v[4:5] op_sel_hi:[1,0]
  v_pk_mul_f32 v[204:205], v[204:205], v[4:5] op_sel_hi:[1,0]
  v_pk_mul_f32 v[206:207], v[206:207], v[4:5] op_sel_hi:[1,0]
  v_cvt_pk_bf16_f32 v156, v200, v201
  v_cvt_pk_bf16_f32 v157, v202, v203
  v_cvt_pk_bf16_f32 v158, v204, v205
  v_cvt_pk_bf16_f32 v159, v206, v207
  v_pk_mul_f32 v[208:209], v[208:209], v[4:5] op_sel_hi:[1,0]
  v_pk_mul_f32 v[210:211], v[210:211], v[4:5] op_sel_hi:[1,0]
  v_pk_mul_f32 v[212:213], v[212:213], v[4:5] op_sel_hi:[1,0]
  s_waitcnt vmcnt(4)
  buffer_load_dwordx4 v[96:99], v0, s[24:27], s58 offen offset:0 nt
  v_pk_mul_f32 v[214:215], v[214:215], v[4:5] op_sel_hi:[1,0]
  v_cvt_pk_bf16_f32 v160, v208, v209
  v_cvt_pk_bf16_f32 v161, v210, v211
  v_cvt_pk_bf16_f32 v162, v212, v213
  v_cvt_pk_bf16_f32 v163, v214, v215
  v_pk_mul_f32 v[216:217], v[216:217], v[4:5] op_sel_hi:[1,0]
  v_pk_mul_f32 v[218:219], v[218:219], v[4:5] op_sel_hi:[1,0]
  v_pk_mul_f32 v[220:221], v[220:221], v[4:5] op_sel_hi:[1,0]
  v_pk_mul_f32 v[222:223], v[222:223], v[4:5] op_sel_hi:[1,0]
  v_cvt_pk_bf16_f32 v164, v216, v217
  v_cvt_pk_bf16_f32 v165, v218, v219
  v_cvt_pk_bf16_f32 v166, v220, v221
  v_cvt_pk_bf16_f32 v167, v222, v223
  v_pk_mul_f32 v[224:225], v[224:225], v[4:5] op_sel_hi:[1,0]
  v_pk_mul_f32 v[226:227], v[226:227], v[4:5] op_sel_hi:[1,0]
  v_pk_mul_f32 v[228:229], v[228:229], v[4:5] op_sel_hi:[1,0]
  v_pk_mul_f32 v[230:231], v[230:231], v[4:5] op_sel_hi:[1,0]
  v_cvt_pk_bf16_f32 v168, v224, v225
  v_cvt_pk_bf16_f32 v169, v226, v227
  v_cvt_pk_bf16_f32 v170, v228, v229
  v_cvt_pk_bf16_f32 v171, v230, v231
  v_pk_mul_f32 v[232:233], v[232:233], v[4:5] op_sel_hi:[1,0]
  v_pk_mul_f32 v[234:235], v[234:235], v[4:5] op_sel_hi:[1,0]
  v_pk_mul_f32 v[236:237], v[236:237], v[4:5] op_sel_hi:[1,0]
  v_pk_mul_f32 v[238:239], v[238:239], v[4:5] op_sel_hi:[1,0]
  v_cvt_pk_bf16_f32 v172, v232, v233
  v_cvt_pk_bf16_f32 v173, v234, v235
  v_cvt_pk_bf16_f32 v174, v236, v237
  v_cvt_pk_bf16_f32 v175, v238, v239
  v_mov_b64 v[192:193], 0
  v_mov_b64 v[194:195], 0
  v_mov_b64 v[196:197], 0
  v_mov_b64 v[198:199], 0
  v_mov_b64 v[200:201], -1
  v_mov_b64 v[202:203], -1
  v_mov_b64 v[204:205], -1
  v_mov_b64 v[206:207], -1
  v_mov_b64 v[208:209], -1
  v_mov_b64 v[210:211], -1
  v_mov_b64 v[212:213], -1
  v_mov_b64 v[214:215], -1
  v_mov_b32_dpp v192, v112 quad_perm:[0,1,2,3] row_mask:0xf bank_mask:0x3
  v_mov_b32_dpp v193, v113 quad_perm:[0,1,2,3] row_mask:0xf bank_mask:0x3
  v_mov_b32_dpp v194, v114 quad_perm:[0,1,2,3] row_mask:0xf bank_mask:0x3
  v_mov_b32_dpp v195, v115 quad_perm:[0,1,2,3] row_mask:0xf bank_mask:0x3
  v_mov_b32_dpp v196, v112 row_ror:8 row_mask:0xf bank_mask:0xc
  v_mov_b32_dpp v197, v113 row_ror:8 row_mask:0xf bank_mask:0xc
  v_mov_b32_dpp v198, v114 row_ror:8 row_mask:0xf bank_mask:0xc
  v_mov_b32_dpp v199, v115 row_ror:8 row_mask:0xf bank_mask:0xc
  s_waitcnt vmcnt(4)
  buffer_load_dwordx4 v[100:103], v0, s[24:27], s58 offen offset:1024 nt
  s_nop 1
  v_mfma_f32_16x16x32_bf16 v[176:179], v[16:19], v[192:195], 0
  v_mfma_f32_16x16x32_bf16 v[180:183], v[20:23], v[192:195], 0
  v_mfma_f32_16x16x32_bf16 v[184:187], v[24:27], v[192:195], 0
  v_mfma_f32_16x16x32_bf16 v[188:191], v[28:31], v[192:195], 0
  v_mfma_f32_16x16x32_bf16 v[176:179], v[32:35], v[196:199], v[176:179]
  v_mfma_f32_16x16x32_bf16 v[180:183], v[36:39], v[196:199], v[180:183]
  v_mfma_f32_16x16x32_bf16 v[184:187], v[40:43], v[196:199], v[184:187]
  v_mfma_f32_16x16x32_bf16 v[188:191], v[44:47], v[196:199], v[188:191]
  v_mov_b32_dpp v192, v112 row_ror:8 row_mask:0xf bank_mask:0x3
  v_mov_b32_dpp v193, v113 row_ror:8 row_mask:0xf bank_mask:0x3
  v_mov_b32_dpp v194, v114 row_ror:8 row_mask:0xf bank_mask:0x3
  v_mov_b32_dpp v195, v115 row_ror:8 row_mask:0xf bank_mask:0x3
  v_mov_b32_dpp v196, v112 quad_perm:[0,1,2,3] row_mask:0xf bank_mask:0xc
  v_mov_b32_dpp v197, v113 quad_perm:[0,1,2,3] row_mask:0xf bank_mask:0xc
  v_mov_b32_dpp v198, v114 quad_perm:[0,1,2,3] row_mask:0xf bank_mask:0xc
  v_mov_b32_dpp v199, v115 quad_perm:[0,1,2,3] row_mask:0xf bank_mask:0xc
  v_perm_b32 v16, v52, v48, s64
  v_perm_b32 v20, v52, v48, s65
  v_perm_b32 v24, v53, v49, s64
  v_perm_b32 v28, v53, v49, s65
  v_perm_b32 v32, v54, v50, s64
  v_perm_b32 v36, v54, v50, s65
  v_perm_b32 v40, v55, v51, s64
  v_perm_b32 v44, v55, v51, s65
  v_perm_b32 v17, v60, v56, s64
  v_perm_b32 v21, v60, v56, s65
  v_perm_b32 v25, v61, v57, s64
  v_perm_b32 v29, v61, v57, s65
  v_perm_b32 v33, v62, v58, s64
  v_perm_b32 v37, v62, v58, s65
  v_perm_b32 v41, v63, v59, s64
  v_perm_b32 v45, v63, v59, s65
  v_perm_b32 v18, v68, v64, s64
  v_perm_b32 v22, v68, v64, s65
  v_perm_b32 v26, v69, v65, s64
  v_perm_b32 v30, v69, v65, s65
  v_perm_b32 v34, v70, v66, s64
  s_waitcnt vmcnt(4)
  buffer_load_dwordx4 v[104:107], v0, s[24:27], s58 offen offset:2048 nt
  v_perm_b32 v38, v70, v66, s65
  v_perm_b32 v42, v71, v67, s64
  v_perm_b32 v46, v71, v67, s65
  v_perm_b32 v19, v76, v72, s64
  v_perm_b32 v23, v76, v72, s65
  v_perm_b32 v27, v77, v73, s64
  v_perm_b32 v31, v77, v73, s65
  v_perm_b32 v35, v78, v74, s64
  v_perm_b32 v39, v78, v74, s65
  v_perm_b32 v43, v79, v75, s64
  v_perm_b32 v47, v79, v75, s65
  s_nop 1
  v_mfma_f32_16x16x32_bf16 v[176:179], v[16:19], v[192:195], v[176:179]
  v_mfma_f32_16x16x32_bf16 v[180:183], v[20:23], v[192:195], v[180:183]
  v_mfma_f32_16x16x32_bf16 v[184:187], v[24:27], v[192:195], v[184:187]
  v_mfma_f32_16x16x32_bf16 v[188:191], v[28:31], v[192:195], v[188:191]
  v_mfma_f32_16x16x32_bf16 v[176:179], v[32:35], v[196:199], v[176:179]
  v_mfma_f32_16x16x32_bf16 v[180:183], v[36:39], v[196:199], v[180:183]
  v_mfma_f32_16x16x32_bf16 v[184:187], v[40:43], v[196:199], v[184:187]
  v_mfma_f32_16x16x32_bf16 v[188:191], v[44:47], v[196:199], v[188:191]
  v_mov_b32_dpp v192, v116 quad_perm:[0,1,2,3] row_mask:0xf bank_mask:0x3
  v_mov_b32_dpp v193, v117 quad_perm:[0,1,2,3] row_mask:0xf bank_mask:0x3
  v_mov_b32_dpp v194, v118 quad_perm:[0,1,2,3] row_mask:0xf bank_mask:0x3
  v_mov_b32_dpp v195, v119 quad_perm:[0,1,2,3] row_mask:0xf bank_mask:0x3
  v_mov_b32_dpp v196, v116 row_ror:8 row_mask:0xf bank_mask:0xc
  v_mov_b32_dpp v197, v117 row_ror:8 row_mask:0xf bank_mask:0xc
  v_mov_b32_dpp v198, v118 row_ror:8 row_mask:0xf bank_mask:0xc
  v_mov_b32_dpp v199, v119 row_ror:8 row_mask:0xf bank_mask:0xc
  v_perm_b32 v16, v84, v80, s64
  v_perm_b32 v20, v84, v80, s65
  v_perm_b32 v24, v85, v81, s64
  v_perm_b32 v28, v85, v81, s65
  v_perm_b32 v32, v86, v82, s64
  v_perm_b32 v36, v86, v82, s65
  v_perm_b32 v40, v87, v83, s64
  v_perm_b32 v44, v87, v83, s65
  s_waitcnt vmcnt(4)
  buffer_load_dwordx4 v[108:111], v0, s[24:27], s58 offen offset:3072 nt
  s_add_u32 s58, s58, 32768
  s_waitcnt vmcnt(4)
  buffer_load_dwordx4 v[48:51], v0, s[24:27], s57 offen offset:0 nt
  v_perm_b32 v17, v92, v88, s64
  v_perm_b32 v21, v92, v88, s65
  s_waitcnt vmcnt(4)
  buffer_load_dwordx4 v[52:55], v0, s[24:27], s57 offen offset:1024 nt
  v_perm_b32 v25, v93, v89, s64
  v_perm_b32 v29, v93, v89, s65
  v_perm_b32 v33, v94, v90, s64
  v_perm_b32 v37, v94, v90, s65
  v_perm_b32 v41, v95, v91, s64
  v_perm_b32 v45, v95, v91, s65
  s_waitcnt vmcnt(4)
  buffer_load_dwordx4 v[56:59], v0, s[24:27], s57 offen offset:2048 nt
  v_perm_b32 v18, v100, v96, s64
  v_perm_b32 v22, v100, v96, s65
  v_perm_b32 v26, v101, v97, s64
  v_perm_b32 v30, v101, v97, s65
  v_perm_b32 v34, v102, v98, s64
  v_perm_b32 v38, v102, v98, s65
  v_perm_b32 v42, v103, v99, s64
  v_perm_b32 v46, v103, v99, s65
  s_waitcnt vmcnt(4)
  buffer_load_dwordx4 v[60:63], v0, s[24:27], s57 offen offset:3072 nt
  s_add_u32 s57, s57, 32768
  s_waitcnt vmcnt(4)
  buffer_load_dwordx4 v[64:67], v0, s[24:27], s58 offen offset:0 nt
  v_perm_b32 v19, v108, v104, s64
  v_perm_b32 v23, v108, v104, s65
  v_perm_b32 v27, v109, v105, s64
  v_perm_b32 v31, v109, v105, s65
  v_perm_b32 v35, v110, v106, s64
  v_perm_b32 v39, v110, v106, s65
  v_perm_b32 v43, v111, v107, s64
  v_perm_b32 v47, v111, v107, s65
  s_nop 1
  v_mfma_f32_16x16x32_bf16 v[176:179], v[16:19], v[192:195], v[176:179]
  v_mfma_f32_16x16x32_bf16 v[180:183], v[20:23], v[192:195], v[180:183]
  v_mfma_f32_16x16x32_bf16 v[184:187], v[24:27], v[192:195], v[184:187]
  v_mfma_f32_16x16x32_bf16 v[188:191], v[28:31], v[192:195], v[188:191]
  v_mfma_f32_16x16x32_bf16 v[176:179], v[32:35], v[196:199], v[176:179]
  v_mfma_f32_16x16x32_bf16 v[180:183], v[36:39], v[196:199], v[180:183]
  v_mfma_f32_16x16x32_bf16 v[184:187], v[40:43], v[196:199], v[184:187]
  v_mfma_f32_16x16x32_bf16 v[188:191], v[44:47], v[196:199], v[188:191]
  v_mov_b32_dpp v192, v116 row_ror:8 row_mask:0xf bank_mask:0x3
  v_mov_b32_dpp v193, v117 row_ror:8 row_mask:0xf bank_mask:0x3
  v_mov_b32_dpp v194, v118 row_ror:8 row_mask:0xf bank_mask:0x3
  v_mov_b32_dpp v195, v119 row_ror:8 row_mask:0xf bank_mask:0x3
  v_mov_b32_dpp v196, v116 quad_perm:[0,1,2,3] row_mask:0xf bank_mask:0xc
  v_mov_b32_dpp v197, v117 quad_perm:[0,1,2,3] row_mask:0xf bank_mask:0xc
  v_mov_b32_dpp v198, v118 quad_perm:[0,1,2,3] row_mask:0xf bank_mask:0xc
  s_waitcnt vmcnt(4)
  buffer_load_dwordx4 v[68:71], v0, s[24:27], s58 offen offset:1024 nt
  v_mov_b32_dpp v199, v119 quad_perm:[0,1,2,3] row_mask:0xf bank_mask:0xc
  s_waitcnt vmcnt(4)
  buffer_load_dwordx4 v[72:75], v0, s[24:27], s58 offen offset:2048 nt
  v_perm_b32 v16, v52, v48, s64
  v_perm_b32 v20, v52, v48, s65
  v_perm_b32 v24, v53, v49, s64
  v_perm_b32 v28, v53, v49, s65
  v_perm_b32 v32, v54, v50, s64
  v_perm_b32 v36, v54, v50, s65
  v_perm_b32 v40, v55, v51, s64
  v_perm_b32 v44, v55, v51, s65
  s_waitcnt vmcnt(4)
  buffer_load_dwordx4 v[76:79], v0, s[24:27], s58 offen offset:3072 nt
  s_add_u32 s58, s58, 32768
  s_waitcnt vmcnt(4)
  buffer_load_dwordx4 v[80:83], v0, s[24:27], s57 offen offset:0 nt
  v_perm_b32 v17, v60, v56, s64
  v_perm_b32 v21, v60, v56, s65
  v_perm_b32 v25, v61, v57, s64
  v_perm_b32 v29, v61, v57, s65
  v_perm_b32 v33, v62, v58, s64
  v_perm_b32 v37, v62, v58, s65
  v_perm_b32 v41, v63, v59, s64
  v_perm_b32 v45, v63, v59, s65
  s_waitcnt vmcnt(4)
  buffer_load_dwordx4 v[84:87], v0, s[24:27], s57 offen offset:1024 nt
  s_waitcnt vmcnt(4)
  buffer_load_dwordx4 v[88:91], v0, s[24:27], s57 offen offset:2048 nt
  v_perm_b32 v18, v68, v64, s64
  v_perm_b32 v22, v68, v64, s65
  v_perm_b32 v26, v69, v65, s64
  v_perm_b32 v30, v69, v65, s65
  v_perm_b32 v34, v70, v66, s64
  v_perm_b32 v38, v70, v66, s65
  v_perm_b32 v42, v71, v67, s64
  v_perm_b32 v46, v71, v67, s65
  s_waitcnt vmcnt(4)
  buffer_load_dwordx4 v[92:95], v0, s[24:27], s57 offen offset:3072 nt
  s_add_u32 s57, s57, 32768
  s_waitcnt vmcnt(4)
  buffer_load_dwordx4 v[96:99], v0, s[24:27], s58 offen offset:0 nt
  v_perm_b32 v19, v76, v72, s64
  v_perm_b32 v23, v76, v72, s65
  v_perm_b32 v27, v77, v73, s64
  v_perm_b32 v31, v77, v73, s65
  v_perm_b32 v35, v78, v74, s64
  v_perm_b32 v39, v78, v74, s65
  v_perm_b32 v43, v79, v75, s64
  v_perm_b32 v47, v79, v75, s65
  s_nop 1
  v_mfma_f32_16x16x32_bf16 v[176:179], v[16:19], v[192:195], v[176:179]
  v_mfma_f32_16x16x32_bf16 v[180:183], v[20:23], v[192:195], v[180:183]
  v_mfma_f32_16x16x32_bf16 v[184:187], v[24:27], v[192:195], v[184:187]
  v_mfma_f32_16x16x32_bf16 v[188:191], v[28:31], v[192:195], v[188:191]
  v_mfma_f32_16x16x32_bf16 v[176:179], v[32:35], v[196:199], v[176:179]
  v_mfma_f32_16x16x32_bf16 v[180:183], v[36:39], v[196:199], v[180:183]
  v_mfma_f32_16x16x32_bf16 v[184:187], v[40:43], v[196:199], v[184:187]
  s_waitcnt vmcnt(4)
  buffer_load_dwordx4 v[100:103], v0, s[24:27], s58 offen offset:1024 nt
  v_mfma_f32_16x16x32_bf16 v[188:191], v[44:47], v[196:199], v[188:191]
  s_waitcnt vmcnt(4)
  buffer_load_dwordx4 v[104:107], v0, s[24:27], s58 offen offset:2048 nt
  s_waitcnt vmcnt(4)
  buffer_load_dwordx4 v[108:111], v0, s[24:27], s58 offen offset:3072 nt
  s_add_u32 s58, s58, 32768
  ds_read_b32 v5, v1
  s_waitcnt lgkmcnt(0)
  v_readfirstlane_b32 s50, v5
  s_mov_b32 s59, 9
.p2align 6
L_vtop:
  s_barrier
  s_cmp_lg_u32 s59, 15
  s_cbranch_scc1 L_nl45
  s_memrealtime s[60:61]
  ds_read_b64 v[4:5], v1 offset:8
  s_waitcnt lgkmcnt(0)
  v_readfirstlane_b32 s76, v4
  v_readfirstlane_b32 s77, v5
  s_cmp_eq_u32 s77, 0
  s_cbranch_scc1 L_nl45
  s_sub_u32 s66, s60, s76
  s_cmp_gt_i32 s66, 13
  s_cselect_b32 s50, 1, 0
L_nl45:
  s_cmp_gt_i32 s50, 0
  s_cselect_b64 vcc, -1, 0
  s_subb_u32 s50, s50, 0
  s_waitcnt vmcnt(7)
  s_cbranch_vccnz L_go46
  s_waitcnt vmcnt(4)
L_go46:
  buffer_load_dwordx4 v[48:51], v0, s[24:27], s57 offen offset:0 nt
  s_waitcnt vmcnt(7)
  s_cbranch_vccnz L_go47
  s_waitcnt vmcnt(4)
L_go47:
  buffer_load_dwordx4 v[52:55], v0, s[24:27], s57 offen offset:1024 nt
  v_mov_b32_dpp v192, v120 quad_perm:[0,1,2,3] row_mask:0xf bank_mask:0x3
  v_mov_b32_dpp v193, v121 quad_perm:[0,1,2,3] row_mask:0xf bank_mask:0x3
  v_mov_b32_dpp v194, v122 quad_perm:[0,1,2,3] row_mask:0xf bank_mask:0x3
  v_mov_b32_dpp v195, v123 quad_perm:[0,1,2,3] row_mask:0xf bank_mask:0x3
  v_mov_b32_dpp v196, v120 row_ror:8 row_mask:0xf bank_mask:0xc
  v_mov_b32_dpp v197, v121 row_ror:8 row_mask:0xf bank_mask:0xc
  v_mov_b32_dpp v198, v122 row_ror:8 row_mask:0xf bank_mask:0xc
  v_mov_b32_dpp v199, v123 row_ror:8 row_mask:0xf bank_mask:0xc
  v_perm_b32 v16, v84, v80, s64
  v_perm_b32 v20, v84, v80, s65
  v_perm_b32 v24, v85, v81, s64
  v_perm_b32 v28, v85, v81, s65
  v_perm_b32 v32, v86, v82, s64
  v_perm_b32 v36, v86, v82, s65
  v_perm_b32 v40, v87, v83, s64
  v_perm_b32 v44, v87, v83, s65
  s_waitcnt vmcnt(7)
  s_cbranch_vccnz L_go48
  s_waitcnt vmcnt(4)
L_go48:
  buffer_load_dwordx4 v[56:59], v0, s[24:27], s57 offen offset:2048 nt
  s_waitcnt vmcnt(7)
  s_cbranch_vccnz L_go49
  s_waitcnt vmcnt(4)
L_go49:
  buffer_load_dwordx4 v[60:63], v0, s[24:27], s57 offen offset:3072 nt
  s_add_u32 s57, s57, 32768
  v_perm_b32 v17, v92, v88, s64
  v_perm_b32 v21, v92, v88, s65
  v_perm_b32 v25, v93, v89, s64
  v_perm_b32 v29, v93, v89, s65
  v_perm_b32 v33, v94, v90, s64
  v_perm_b32 v37, v94, v90, s65
  v_perm_b32 v41, v95, v91, s64
  v_perm_b32 v45, v95, v91, s65
  s_waitcnt vmcnt(7)
  s_cbranch_vccnz L_go50
  s_waitcnt vmcnt(4)
L_go50:
  buffer_load_dwordx4 v[64:67], v0, s[24:27], s58 offen offset:0 nt
  s_waitcnt vmcnt(7)
  s_cbranch_vccnz L_go51
  s_waitcnt vmcnt(4)
L_go51:
  buffer_load_dwordx4 v[68:71], v0, s[24:27], s58 offen offset:1024 nt
  v_perm_b32 v18, v100, v96, s64
  v_perm_b32 v22, v100, v96, s65
  v_perm_b32 v26, v101, v97, s64
  v_perm_b32 v30, v101, v97, s65
  v_perm_b32 v34, v102, v98, s64
  v_perm_b32 v38, v102, v98, s65
  v_perm_b32 v42, v103, v99, s64
  v_perm_b32 v46, v103, v99, s65
  s_waitcnt vmcnt(7)
  s_cbranch_vccnz L_go52
  s_waitcnt vmcnt(4)
L_go52:
  buffer_load_dwordx4 v[72:75], v0, s[24:27], s58 offen offset:2048 nt
  s_waitcnt vmcnt(7)
  s_cbranch_vccnz L_go53
  s_waitcnt vmcnt(4)
L_go53:
  buffer_load_dwordx4 v[76:79], v0, s[24:27], s58 offen offset:3072 nt
  s_add_u32 s58, s58, 32768
  v_perm_b32 v19, v108, v104, s64
  v_perm_b32 v23, v108, v104, s65
  v_perm_b32 v27, v109, v105, s64
  v_perm_b32 v31, v109, v105, s65
  v_perm_b32 v35, v110, v106, s64
  v_perm_b32 v39, v110, v106, s65
  v_perm_b32 v43, v111, v107, s64
  v_perm_b32 v47, v111, v107, s65
  s_nop 1
  v_mfma_f32_16x16x32_bf16 v[176:179], v[16:19], v[192:195], v[176:179]
  v_mfma_f32_16x16x32_bf16 v[180:183], v[20:23], v[192:195], v[180:183]
  v_mfma_f32_16x16x32_bf16 v[184:187], v[24:27], v[192:195], v[184:187]
  v_mfma_f32_16x16x32_bf16 v[188:191], v[28:31], v[192:195], v[188:191]
  v_mfma_f32_16x16x32_bf16 v[176:179], v[32:35], v[196:199], v[176:179]
  v_mfma_f32_16x16x32_bf16 v[180:183], v[36:39], v[196:199], v[180:183]
  v_mfma_f32_16x16x32_bf16 v[184:187], v[40:43], v[196:199], v[184:187]
  v_mfma_f32_16x16x32_bf16 v[188:191], v[44:47], v[196:199], v[188:191]
  s_cmp_lg_u32 s59, 15
  s_cbranch_scc1 L_nl54
  s_memrealtime s[60:61]
  s_add_u32 s76, s76, s77
  s_waitcnt lgkmcnt(0)
  s_cmp_eq_u32 s77, 0
  s_cbranch_scc1 L_nl54
  s_sub_u32 s66, s60, s76
  s_cmp_gt_i32 s66, 13
  s_cselect_b32 s50, 1, 0
L_nl54:
  s_cmp_gt_i32 s50, 0
  s_cselect_b64 vcc, -1, 0
  s_subb_u32 s50, s50, 0
  s_waitcnt vmcnt(7)
  s_cbranch_vccnz L_go55
  s_waitcnt vmcnt(4)
L_go55:
  buffer_load_dwordx4 v[80:83], v0, s[24:27], s57 offen offset:0 nt
  s_waitcnt vmcnt(7)
  s_cbranch_vccnz L_go56
  s_waitcnt vmcnt(4)
L_go56:
  buffer_load_dwordx4 v[84:87], v0, s[24:27], s57 offen offset:1024 nt
  v_mov_b32_dpp v192, v120 row_ror:8 row_mask:0xf bank_mask:0x3
  v_mov_b32_dpp v193, v121 row_ror:8 row_mask:0xf bank_mask:0x3
  v_mov_b32_dpp v194, v122 row_ror:8 row_mask:0xf bank_mask:0x3
  v_mov_b32_dpp v195, v123 row_ror:8 row_mask:0xf bank_mask:0x3
  v_mov_b32_dpp v196, v120 quad_perm:[0,1,2,3] row_mask:0xf bank_mask:0xc
  v_mov_b32_dpp v197, v121 quad_perm:[0,1,2,3] row_mask:0xf bank_mask:0xc
  v_mov_b32_dpp v198, v122 quad_perm:[0,1,2,3] row_mask:0xf bank_mask:0xc
  v_mov_b32_dpp v199, v123 quad_perm:[0,1,2,3] row_mask:0xf bank_mask:0xc
  v_perm_b32 v16, v52, v48, s64
  v_perm_b32 v20, v52, v48, s65
  v_perm_b32 v24, v53, v49, s64
  v_perm_b32 v28, v53, v49, s65
  v_perm_b32 v32, v54, v50, s64
  v_perm_b32 v36, v54, v50, s65
  v_perm_b32 v40, v55, v51, s64
  v_perm_b32 v44, v55, v51, s65
  s_waitcnt vmcnt(7)
  s_cbranch_vccnz L_go57
  s_waitcnt vmcnt(4)
L_go57:
  buffer_load_dwordx4 v[88:91], v0, s[24:27], s57 offen offset:2048 nt
  s_waitcnt vmcnt(7)
  s_cbranch_vccnz L_go58
  s_waitcnt vmcnt(4)
L_go58:
  buffer_load_dwordx4 v[92:95], v0, s[24:27], s57 offen offset:3072 nt
  s_add_u32 s57, s57, 32768
  v_perm_b32 v17, v60, v56, s64
  v_perm_b32 v21, v60, v56, s65
  v_perm_b32 v25, v61, v57, s64
  v_perm_b32 v29, v61, v57, s65
  v_perm_b32 v33, v62, v58, s64
  v_perm_b32 v37, v62, v58, s65
  v_perm_b32 v41, v63, v59, s64
  v_perm_b32 v45, v63, v59, s65
  s_waitcnt vmcnt(7)
  s_cbranch_vccnz L_go59
  s_waitcnt vmcnt(4)
L_go59:
  buffer_load_dwordx4 v[96:99], v0, s[24:27], s58 offen offset:0 nt
  s_waitcnt vmcnt(7)
  s_cbranch_vccnz L_go60
  s_waitcnt vmcnt(4)
L_go60:
  buffer_load_dwordx4 v[100:103], v0, s[24:27], s58 offen offset:1024 nt
  v_perm_b32 v18, v68, v64, s64
  v_perm_b32 v22, v68, v64, s65
  v_perm_b32 v26, v69, v65, s64
  v_perm_b32 v30, v69, v65, s65
  v_perm_b32 v34, v70, v66, s64
  v_perm_b32 v38, v70, v66, s65
  v_perm_b32 v42, v71, v67, s64
  v_perm_b32 v46, v71, v67, s65
  s_waitcnt vmcnt(7)
  s_cbranch_vccnz L_go61
  s_waitcnt vmcnt(4)
L_go61:
  buffer_load_dwordx4 v[104:107], v0, s[24:27], s58 offen offset:2048 nt
  s_waitcnt vmcnt(7)
  s_cbranch_vccnz L_go62
  s_waitcnt vmcnt(4)
L_go62:
  buffer_load_dwordx4 v[108:111], v0, s[24:27], s58 offen offset:3072 nt
  s_add_u32 s58, s58, 32768
  v_perm_b32 v19, v76, v72, s64
  v_perm_b32 v23, v76, v72, s65
  v_perm_b32 v27, v77, v73, s64
  v_perm_b32 v31, v77, v73, s65
  v_perm_b32 v35, v78, v74, s64
  v_perm_b32 v39, v78, v74, s65
  v_perm_b32 v43, v79, v75, s64
  v_perm_b32 v47, v79, v75, s65
  s_nop 1
  v_mfma_f32_16x16x32_bf16 v[176:179], v[16:19], v[192:195], v[176:179]
  v_mfma_f32_16x16x32_bf16 v[180:183], v[20:23], v[192:195], v[180:183]
  v_mfma_f32_16x16x32_bf16 v[184:187], v[24:27], v[192:195], v[184:187]
  v_mfma_f32_16x16x32_bf16 v[188:191], v[28:31], v[192:195], v[188:191]
  v_mfma_f32_16x16x32_bf16 v[176:179], v[32:35], v[196:199], v[176:179]
  v_mfma_f32_16x16x32_bf16 v[180:183], v[36:39], v[196:199], v[180:183]
  v_mfma_f32_16x16x32_bf16 v[184:187], v[40:43], v[196:199], v[184:187]
  v_mfma_f32_16x16x32_bf16 v[188:191], v[44:47], v[196:199], v[188:191]
  s_barrier
  s_bitcmp1_b32 s59, 0
  s_cbranch_scc1 L_nb63
  ds_read_b32 v5, v1
  s_waitcnt lgkmcnt(0)
  v_readfirstlane_b32 s50, v5
L_nb63:
  s_cmp_lg_u32 s59, 15
  s_cbranch_scc1 L_nl63
  s_memrealtime s[60:61]
  s_add_u32 s76, s76, s77
  s_waitcnt lgkmcnt(0)
  s_cmp_eq_u32 s77, 0
  s_cbranch_scc1 L_nl63
  s_sub_u32 s66, s60, s76
  s_cmp_gt_i32 s66, 13
  s_cselect_b32 s50, 1, 0
L_nl63:
  s_cmp_gt_i32 s50, 0
  s_cselect_b64 vcc, -1, 0
  s_subb_u32 s50, s50, 0
  s_waitcnt vmcnt(7)
  s_cbranch_vccnz L_go64
  s_waitcnt vmcnt(4)
L_go64:
  buffer_load_dwordx4 v[48:51], v0, s[24:27], s57 offen offset:0 nt
  s_waitcnt vmcnt(7)
  s_cbranch_vccnz L_go65
  s_waitcnt vmcnt(4)
L_go65:
  buffer_load_dwordx4 v[52:55], v0, s[24:27], s57 offen offset:1024 nt
  v_mov_b32_dpp v192, v124 quad_perm:[0,1,2,3] row_mask:0xf bank_mask:0x3
  v_mov_b32_dpp v193, v125 quad_perm:[0,1,2,3] row_mask:0xf bank_mask:0x3
  v_mov_b32_dpp v194, v126 quad_perm:[0,1,2,3] row_mask:0xf bank_mask:0x3
  v_mov_b32_dpp v195, v127 quad_perm:[0,1,2,3] row_mask:0xf bank_mask:0x3
  v_mov_b32_dpp v196, v124 row_ror:8 row_mask:0xf bank_mask:0xc
  v_mov_b32_dpp v197, v125 row_ror:8 row_mask:0xf bank_mask:0xc
  v_mov_b32_dpp v198, v126 row_ror:8 row_mask:0xf bank_mask:0xc
  v_mov_b32_dpp v199, v127 row_ror:8 row_mask:0xf bank_mask:0xc
  v_perm_b32 v16, v84, v80, s64
  v_perm_b32 v20, v84, v80, s65
  v_perm_b32 v24, v85, v81, s64
  v_perm_b32 v28, v85, v81, s65
  v_perm_b32 v32, v86, v82, s64
  v_perm_b32 v36, v86, v82, s65
  v_perm_b32 v40, v87, v83, s64
  v_perm_b32 v44, v87, v83, s65
  s_waitcnt vmcnt(7)
  s_cbranch_vccnz L_go66
  s_waitcnt vmcnt(4)
L_go66:
  buffer_load_dwordx4 v[56:59], v0, s[24:27], s57 offen offset:2048 nt
  s_waitcnt vmcnt(7)
  s_cbranch_vccnz L_go67
  s_waitcnt vmcnt(4)
L_go67:
  buffer_load_dwordx4 v[60:63], v0, s[24:27], s57 offen offset:3072 nt
  s_add_u32 s57, s57, 32768
  v_perm_b32 v17, v92, v88, s64
  v_perm_b32 v21, v92, v88, s65
  v_perm_b32 v25, v93, v89, s64
  v_perm_b32 v29, v93, v89, s65
  v_perm_b32 v33, v94, v90, s64
  v_perm_b32 v37, v94, v90, s65
  v_perm_b32 v41, v95, v91, s64
  v_perm_b32 v45, v95, v91, s65
  s_waitcnt vmcnt(7)
  s_cbranch_vccnz L_go68
  s_waitcnt vmcnt(4)
L_go68:
  buffer_load_dwordx4 v[64:67], v0, s[24:27], s58 offen offset:0 nt
  s_waitcnt vmcnt(7)
  s_cbranch_vccnz L_go69
  s_waitcnt vmcnt(4)
L_go69:
  buffer_load_dwordx4 v[68:71], v0, s[24:27], s58 offen offset:1024 nt
  v_perm_b32 v18, v100, v96, s64
  v_perm_b32 v22, v100, v96, s65
  v_perm_b32 v26, v101, v97, s64
  v_perm_b32 v30, v101, v97, s65
  v_perm_b32 v34, v102, v98, s64
  v_perm_b32 v38, v102, v98, s65
  v_perm_b32 v42, v103, v99, s64
  v_perm_b32 v46, v103, v99, s65
  s_waitcnt vmcnt(7)
  s_cbranch_vccnz L_go70
  s_waitcnt vmcnt(4)
L_go70:
  buffer_load_dwordx4 v[72:75], v0, s[24:27], s58 offen offset:2048 nt
  s_waitcnt vmcnt(7)
  s_cbranch_vccnz L_go71
  s_waitcnt vmcnt(4)
L_go71:
  buffer_load_dwordx4 v[76:79], v0, s[24:27], s58 offen offset:3072 nt
  s_add_u32 s58, s58, 32768
  v_perm_b32 v19, v108, v104, s64
  v_perm_b32 v23, v108, v104, s65
  v_perm_b32 v27, v109, v105, s64
  v_perm_b32 v31, v109, v105, s65
  v_perm_b32 v35, v110, v106, s64
  v_perm_b32 v39, v110, v106, s65
  v_perm_b32 v43, v111, v107, s64
  v_perm_b32 v47, v111, v107, s65
  s_nop 1
  v_mfma_f32_16x16x32_bf16 v[176:179], v[16:19], v[192:195], v[176:179]
  v_mfma_f32_16x16x32_bf16 v[180:183], v[20:23], v[192:195], v[180:183]
  v_mfma_f32_16x16x32_bf16 v[184:187], v[24:27], v[192:195], v[184:187]
  v_mfma_f32_16x16x32_bf16 v[188:191], v[28:31], v[192:195], v[188:191]
  v_mfma_f32_16x16x32_bf16 v[176:179], v[32:35], v[196:199], v[176:179]
  v_mfma_f32_16x16x32_bf16 v[180:183], v[36:39], v[196:199], v[180:183]
  v_mfma_f32_16x16x32_bf16 v[184:187], v[40:43], v[196:199], v[184:187]
  v_mfma_f32_16x16x32_bf16 v[188:191], v[44:47], v[196:199], v[188:191]
  s_cmp_eq_u32 s59, 15
  s_cbranch_scc1 L_final
  s_cmp_gt_i32 s50, 0
  s_cselect_b64 vcc, -1, 0
  s_subb_u32 s50, s50, 0
  s_waitcnt vmcnt(7)
  s_cbranch_vccnz L_go73
  s_waitcnt vmcnt(4)
L_go73:
  buffer_load_dwordx4 v[80:83], v0, s[24:27], s57 offen offset:0 nt
  s_waitcnt vmcnt(7)
  s_cbranch_vccnz L_go74
  s_waitcnt vmcnt(4)
L_go74:
  buffer_load_dwordx4 v[84:87], v0, s[24:27], s57 offen offset:1024 nt
  v_mov_b32_dpp v192, v124 row_ror:8 row_mask:0xf bank_mask:0x3
  v_mov_b32_dpp v193, v125 row_ror:8 row_mask:0xf bank_mask:0x3
  v_mov_b32_dpp v194, v126 row_ror:8 row_mask:0xf bank_mask:0x3
  v_mov_b32_dpp v195, v127 row_ror:8 row_mask:0xf bank_mask:0x3
  v_mov_b32_dpp v196, v124 quad_perm:[0,1,2,3] row_mask:0xf bank_mask:0xc
  v_mov_b32_dpp v197, v125 quad_perm:[0,1,2,3] row_mask:0xf bank_mask:0xc
  v_mov_b32_dpp v198, v126 quad_perm:[0,1,2,3] row_mask:0xf bank_mask:0xc
  v_mov_b32_dpp v199, v127 quad_perm:[0,1,2,3] row_mask:0xf bank_mask:0xc
  v_perm_b32 v16, v52, v48, s64
  v_perm_b32 v20, v52, v48, s65
  v_perm_b32 v24, v53, v49, s64
  v_perm_b32 v28, v53, v49, s65
  v_perm_b32 v32, v54, v50, s64
  v_perm_b32 v36, v54, v50, s65
  v_perm_b32 v40, v55, v51, s64
  v_perm_b32 v44, v55, v51, s65
  v_mov_b64 v[120:121], v[128:129]
  v_mov_b64 v[122:123], v[130:131]
  v_mov_b64 v[124:125], v[132:133]
  v_mov_b64 v[126:127], v[134:135]
  v_mov_b64 v[128:129], v[136:137]
  v_mov_b64 v[130:131], v[138:139]
  v_mov_b64 v[132:133], v[140:141]
  v_mov_b64 v[134:135], v[142:143]
  s_waitcnt vmcnt(7)
  s_cbranch_vccnz L_go75
  s_waitcnt vmcnt(4)
L_go75:
  buffer_load_dwordx4 v[88:91], v0, s[24:27], s57 offen offset:2048 nt
  s_waitcnt vmcnt(7)
  s_cbranch_vccnz L_go76
  s_waitcnt vmcnt(4)
L_go76:
  buffer_load_dwordx4 v[92:95], v0, s[24:27], s57 offen offset:3072 nt
  s_add_u32 s57, s57, 32768
  v_perm_b32 v17, v60, v56, s64
  v_perm_b32 v21, v60, v56, s65
  v_perm_b32 v25, v61, v57, s64
  v_perm_b32 v29, v61, v57, s65
  v_perm_b32 v33, v62, v58, s64
  v_perm_b32 v37, v62, v58, s65
  v_perm_b32 v41, v63, v59, s64
  v_perm_b32 v45, v63, v59, s65
  v_mov_b64 v[136:137], v[144:145]
  v_mov_b64 v[138:139], v[146:147]
  v_mov_b64 v[140:141], v[148:149]
  v_mov_b64 v[142:143], v[150:151]
  v_mov_b64 v[144:145], v[152:153]
  v_mov_b64 v[146:147], v[154:155]
  v_mov_b64 v[148:149], v[156:157]
  v_mov_b64 v[150:151], v[158:159]
  s_waitcnt vmcnt(7)
  s_cbranch_vccnz L_go77
  s_waitcnt vmcnt(4)
L_go77:
  buffer_load_dwordx4 v[96:99], v0, s[24:27], s58 offen offset:0 nt
  s_waitcnt vmcnt(7)
  s_cbranch_vccnz L_go78
  s_waitcnt vmcnt(4)
L_go78:
  buffer_load_dwordx4 v[100:103], v0, s[24:27], s58 offen offset:1024 nt
  v_perm_b32 v18, v68, v64, s64
  v_perm_b32 v22, v68, v64, s65
  v_perm_b32 v26, v69, v65, s64
  v_perm_b32 v30, v69, v65, s65
  v_perm_b32 v34, v70, v66, s64
  v_perm_b32 v38, v70, v66, s65
  v_perm_b32 v42, v71, v67, s64
  v_perm_b32 v46, v71, v67, s65
  v_mov_b64 v[152:153], v[160:161]
  v_mov_b64 v[154:155], v[162:163]
  v_mov_b64 v[156:157], v[164:165]
  v_mov_b64 v[158:159], v[166:167]
  v_mov_b64 v[160:161], v[168:169]
  v_mov_b64 v[162:163], v[170:171]
  v_mov_b64 v[164:165], v[172:173]
  v_mov_b64 v[166:167], v[174:175]
  s_waitcnt vmcnt(7)
  s_cbranch_vccnz L_go79
  s_waitcnt vmcnt(4)
L_go79:
  buffer_load_dwordx4 v[104:107], v0, s[24:27], s58 offen offset:2048 nt
  s_waitcnt vmcnt(7)
  s_cbranch_vccnz L_go80
  s_waitcnt vmcnt(4)
L_go80:
  buffer_load_dwordx4 v[108:111], v0, s[24:27], s58 offen offset:3072 nt
  s_add_u32 s58, s58, 32768
  v_perm_b32 v19, v76, v72, s64
  v_perm_b32 v23, v76, v72, s65
  v_perm_b32 v27, v77, v73, s64
  v_perm_b32 v31, v77, v73, s65
  v_perm_b32 v35, v78, v74, s64
  v_perm_b32 v39, v78, v74, s65
  v_perm_b32 v43, v79, v75, s64
  v_perm_b32 v47, v79, v75, s65
  s_nop 1
  v_mfma_f32_16x16x32_bf16 v[176:179], v[16:19], v[192:195], v[176:179]
  v_mfma_f32_16x16x32_bf16 v[180:183], v[20:23], v[192:195], v[180:183]
  v_mfma_f32_16x16x32_bf16 v[184:187], v[24:27], v[192:195], v[184:187]
  v_mfma_f32_16x16x32_bf16 v[188:191], v[28:31], v[192:195], v[188:191]
  v_mfma_f32_16x16x32_bf16 v[176:179], v[32:35], v[196:199], v[176:179]
  v_mfma_f32_16x16x32_bf16 v[180:183], v[36:39], v[196:199], v[180:183]
  v_mfma_f32_16x16x32_bf16 v[184:187], v[40:43], v[196:199], v[184:187]
  v_mfma_f32_16x16x32_bf16 v[188:191], v[44:47], v[196:199], v[188:191]
  s_add_u32 s59, s59, 1
  s_branch L_vtop
L_final:
  s_waitcnt vmcnt(7)
  s_waitcnt vmcnt(6)
  v_mov_b32_dpp v192, v124 row_ror:8 row_mask:0xf bank_mask:0x3
  v_mov_b32_dpp v193, v125 row_ror:8 row_mask:0xf bank_mask:0x3
  v_mov_b32_dpp v194, v126 row_ror:8 row_mask:0xf bank_mask:0x3
  v_mov_b32_dpp v195, v127 row_ror:8 row_mask:0xf bank_mask:0x3
  v_mov_b32_dpp v196, v124 quad_perm:[0,1,2,3] row_mask:0xf bank_mask:0xc
  v_mov_b32_dpp v197, v125 quad_perm:[0,1,2,3] row_mask:0xf bank_mask:0xc
  v_mov_b32_dpp v198, v126 quad_perm:[0,1,2,3] row_mask:0xf bank_mask:0xc
  v_mov_b32_dpp v199, v127 quad_perm:[0,1,2,3] row_mask:0xf bank_mask:0xc
  v_perm_b32 v16, v52, v48, s64
  v_perm_b32 v20, v52, v48, s65
  v_perm_b32 v24, v53, v49, s64
  v_perm_b32 v28, v53, v49, s65
  v_perm_b32 v32, v54, v50, s64
  v_perm_b32 v36, v54, v50, s65
  v_perm_b32 v40, v55, v51, s64
  v_perm_b32 v44, v55, v51, s65
  s_waitcnt vmcnt(5)
  s_waitcnt vmcnt(4)
  v_perm_b32 v17, v60, v56, s64
  v_perm_b32 v21, v60, v56, s65
  v_perm_b32 v25, v61, v57, s64
  v_perm_b32 v29, v61, v57, s65
  v_perm_b32 v33, v62, v58, s64
  v_perm_b32 v37, v62, v58, s65
  v_perm_b32 v41, v63, v59, s64
  v_perm_b32 v45, v63, v59, s65
  s_waitcnt vmcnt(3)
  s_waitcnt vmcnt(2)
  v_perm_b32 v18, v68, v64, s64
  v_perm_b32 v22, v68, v64, s65
  v_perm_b32 v26, v69, v65, s64
  v_perm_b32 v30, v69, v65, s65
  v_perm_b32 v34, v70, v66, s64
  v_perm_b32 v38, v70, v66, s65
  v_perm_b32 v42, v71, v67, s64
  v_perm_b32 v46, v71, v67, s65
  s_waitcnt vmcnt(0)
  v_perm_b32 v19, v76, v72, s64
  v_perm_b32 v35, v78, v74, s64
  v_perm_b32 v23, v76, v72, s65
  v_mfma_f32_16x16x32_bf16 v[176:179], v[16:19], v[192:195], v[176:179]
  v_perm_b32 v39, v78, v74, s65
  v_mfma_f32_16x16x32_bf16 v[176:179], v[32:35], v[196:199], v[176:179]
  v_perm_b32 v27, v77, v73, s64
  v_mfma_f32_16x16x32_bf16 v[180:183], v[20:23], v[192:195], v[180:183]
  v_perm_b32 v43, v79, v75, s64
  v_mfma_f32_16x16x32_bf16 v[180:183], v[36:39], v[196:199], v[180:183]
  v_perm_b32 v31, v77, v73, s65
  v_mfma_f32_16x16x32_bf16 v[184:187], v[24:27], v[192:195], v[184:187]
  v_perm_b32 v47, v79, v75, s65
  v_mfma_f32_16x16x32_bf16 v[184:187], v[40:43], v[196:199], v[184:187]
  ds_write_b128 v240, v[176:179] offset:0
  v_mfma_f32_16x16x32_bf16 v[188:191], v[28:31], v[192:195], v[188:191]
  v_mfma_f32_16x16x32_bf16 v[188:191], v[44:47], v[196:199], v[188:191]
  s_nop 0
  ds_write_b128 v240, v[180:183] offset:1024
  s_nop 2
  ds_write_b128 v240, v[184:187] offset:2048
  s_nop 1
  ds_write_b128 v240, v[188:191] offset:3072
  s_waitcnt lgkmcnt(0)
  s_barrier
  s_cmp_ge_u32 s52, 2
  s_cbranch_scc1 L_sdone
  s_mov_b32 s59, 0x200000
  s_mov_b32 s55, 4096
  s_barrier
  buffer_load_dwordx4 v[200:203], v242, s[40:43], 0 offen offset:0 sc1
  buffer_load_dwordx4 v[204:207], v242, s[40:43], 0 offen offset:2048 sc1
  buffer_load_dwordx4 v[208:211], v242, s[40:43], s55 offen offset:0 sc1
  buffer_load_dwordx4 v[212:215], v242, s[40:43], s55 offen offset:2048 sc1
L_poll:
  s_waitcnt vmcnt(0)
  v_max3_u32 v112, v200, v201, v202
  v_max3_u32 v113, v204, v205, v206
  v_max3_u32 v114, v208, v209, v210
  v_max3_u32 v115, v212, v213, v214
  v_max_u32 v112, v112, v203
  v_max_u32 v113, v113, v207
  v_max_u32 v114, v114, v211
  v_max_u32 v115, v115, v215
  v_cmp_eq_u32 s[68:69], -1, v112
  v_cmp_eq_u32 s[70:71], -1, v113
  v_cmp_eq_u32 s[72:73], -1, v114
  v_cmp_eq_u32 s[74:75], -1, v115
  s_bcnt1_i32_b64 s66, s[68:69]
  s_bcnt1_i32_b64 s67, s[70:71]
  s_add_u32 s66, s66, s67
  s_bcnt1_i32_b64 s67, s[72:73]
  s_add_u32 s66, s66, s67
  s_bcnt1_i32_b64 s67, s[74:75]
  s_add_u32 s66, s66, s67
  s_cmp_eq_u32 s66, 0
  s_cbranch_scc1 L_pdone
  s_cmp_le_u32 s66, 64
  s_cbranch_scc1 L_tier0
  s_sleep 12
L_tier0:
  s_mov_b64 exec, s[68:69]
  s_cbranch_execz L_pskip0
  buffer_load_dwordx4 v[200:203], v242, s[40:43], 0 offen offset:0 sc1
L_pskip0:
  s_mov_b64 exec, s[70:71]
  s_cbranch_execz L_pskip1
  buffer_load_dwordx4 v[204:207], v242, s[40:43], 0 offen offset:2048 sc1
L_pskip1:
  s_mov_b64 exec, s[72:73]
  s_cbranch_execz L_pskip2
  buffer_load_dwordx4 v[208:211], v242, s[40:43], s55 offen offset:0 sc1
L_pskip2:
  s_mov_b64 exec, s[74:75]
  s_cbranch_execz L_pskip3
  buffer_load_dwordx4 v[212:215], v242, s[40:43], s55 offen offset:2048 sc1
L_pskip3:
  s_mov_b64 exec, -1
  s_sub_u32 s59, s59, 1
  s_and_b32 s66, s59, 0xff
  s_cbranch_scc1 L_poll
  s_memrealtime s[60:61]
  s_lshl_b32 s66, s2, 7
  s_add_u32 s66, s66, 0xa0000
  s_waitcnt lgkmcnt(0)
  v_mov_b32 v4, s60
  v_mov_b32 v5, s61
  s_mov_b64 exec, 1
  buffer_store_dwordx2 v[4:5], off, s[40:43], s66 sc1
  s_mov_b64 exec, -1
  s_cmp_lg_u32 s59, 0
  s_cbranch_scc1 L_poll
L_pdone:
  v_mfma_f32_16x16x32_bf16 v[120:123], v[244:247], v[200:203], 0
  v_mfma_f32_16x16x32_bf16 v[120:123], v[244:247], v[204:207], v[120:123]
  v_mfma_f32_16x16x32_bf16 v[120:123], v[244:247], v[208:211], v[120:123]
  v_mfma_f32_16x16x32_bf16 v[120:123], v[244:247], v[212:215], v[120:123]
  s_nop 7
  v_add_f32_dpp v120, v120, v120 row_ror:8 row_mask:0xf bank_mask:0xf
  v_add_f32_dpp v121, v121, v121 row_ror:8 row_mask:0xf bank_mask:0xf
  v_add_f32_dpp v122, v122, v122 row_ror:8 row_mask:0xf bank_mask:0xf
  v_add_f32_dpp v123, v123, v123 row_ror:8 row_mask:0xf bank_mask:0xf
  v_cvt_pk_bf16_f32 v120, v120, v121
  v_cvt_pk_bf16_f32 v122, v122, v123
  s_nop 1
  v_permlane32_swap_b32 v120, v122
  s_mov_b32 exec_lo, 0x00ff00ff
  s_mov_b32 exec_hi, 0x00ff00ff
  buffer_store_dword v120, v243, s[44:47], 0 offen sc1
  s_mov_b64 exec, -1
L_sdone:
  s_endpgm
.p2align 6
L_prest:
  s_lshl_b32 s3, s54, 17
  s_add_u32 s36, s12, s3
  s_addc_u32 s37, s13, 0
  s_mov_b32 s38, 0x20000
  s_mov_b32 s39, 0x20000
  v_lshlrev_b32 v10, 7, v2
  s_lshl_b32 s57, s53, 14
  s_lshl_b32 s58, s52, 12
  s_add_u32 s57, s57, s58
  s_mov_b32 exec_hi, 0
  buffer_load_dword v11, v10, s[36:39], s57 offen
  s_mov_b64 exec, -1
  s_waitcnt vmcnt(4)
  buffer_load_dwordx4 v[112:115], v3, s[32:35], s66 offen
  s_add_u32 s66, s66, 8192
  s_waitcnt vmcnt(4)
  buffer_load_dwordx4 v[116:119], v3, s[32:35], s66 offen
  s_add_u32 s66, s66, 8192
  v_perm_b32 v60, v100, v96, s64
  v_perm_b32 v64, v100, v96, s65
  v_perm_b32 v68, v101, v97, s64
  v_perm_b32 v72, v101, v97, s65
  v_perm_b32 v76, v102, v98, s64
  v_perm_b32 v80, v102, v98, s65
  v_perm_b32 v84, v103, v99, s64
  v_perm_b32 v88, v103, v99, s65
  s_waitcnt vmcnt(4)
  buffer_load_dwordx4 v[120:123], v3, s[32:35], s66 offen
  s_add_u32 s66, s66, 8192
  s_waitcnt vmcnt(4)
  buffer_load_dwordx4 v[124:127], v3, s[32:35], s66 offen
  s_add_u32 s66, s66, 204800
  v_perm_b32 v61, v108, v104, s64
  v_perm_b32 v65, v108, v104, s65
  v_perm_b32 v69, v109, v105, s64
  v_perm_b32 v73, v109, v105, s65
  v_perm_b32 v77, v110, v106, s64
  v_perm_b32 v81, v110, v106, s65
  v_perm_b32 v85, v111, v107, s64
  v_perm_b32 v89, v111, v107, s65
  s_waitcnt vmcnt(3)
  buffer_load_dwordx4 v[128:131], v3, s[32:35], s66 offen
  s_add_u32 s66, s66, 8192
  s_waitcnt vmcnt(3)
  buffer_load_dwordx4 v[132:135], v3, s[32:35], s66 offen
  s_add_u32 s66, s66, 8192
  v_perm_b32 v62, v116, v112, s64
  v_perm_b32 v66, v116, v112, s65
  v_perm_b32 v70, v117, v113, s64
  v_perm_b32 v74, v117, v113, s65
  v_perm_b32 v78, v118, v114, s64
  v_perm_b32 v82, v118, v114, s65
  v_perm_b32 v86, v119, v115, s64
  v_perm_b32 v90, v119, v115, s65
  s_waitcnt vmcnt(3)
  buffer_load_dwordx4 v[136:139], v3, s[32:35], s66 offen
  s_add_u32 s66, s66, 8192
  s_waitcnt vmcnt(3)
  buffer_load_dwordx4 v[140:143], v3, s[32:35], s66 offen
  s_add_u32 s66, s66, 8192
  v_perm_b32 v63, v124, v120, s64
  v_perm_b32 v67, v124, v120, s65
  v_perm_b32 v71, v125, v121, s64
  v_perm_b32 v75, v125, v121, s65
  v_perm_b32 v79, v126, v122, s64
  v_perm_b32 v83, v126, v122, s65
  v_perm_b32 v87, v127, v123, s64
  v_perm_b32 v91, v127, v123, s65
  s_nop 1
  v_mfma_f32_16x16x32_bf16 v[28:31], v[60:63], v[12:15], 0
  v_mfma_f32_16x16x32_bf16 v[32:35], v[64:67], v[12:15], 0
  v_mfma_f32_16x16x32_bf16 v[36:39], v[68:71], v[12:15], 0
  v_mfma_f32_16x16x32_bf16 v[40:43], v[72:75], v[12:15], 0
  v_mfma_f32_16x16x32_bf16 v[44:47], v[76:79], v[12:15], 0
  v_mfma_f32_16x16x32_bf16 v[48:51], v[80:83], v[12:15], 0
  v_mfma_f32_16x16x32_bf16 v[52:55], v[84:87], v[12:15], 0
  v_mfma_f32_16x16x32_bf16 v[56:59], v[88:91], v[12:15], 0
  s_waitcnt vmcnt(3)
  buffer_load_dwordx4 v[144:147], v3, s[32:35], s66 offen
  s_add_u32 s66, s66, 8192
  s_waitcnt vmcnt(3)
  buffer_load_dwordx4 v[148:151], v3, s[32:35], s66 offen
  s_add_u32 s66, s66, 8192
  v_perm_b32 v60, v132, v128, s64
  v_perm_b32 v64, v132, v128, s65
  v_perm_b32 v68, v133, v129, s64
  v_perm_b32 v72, v133, v129, s65
  v_perm_b32 v76, v134, v130, s64
  v_perm_b32 v80, v134, v130, s65
  v_perm_b32 v84, v135, v131, s64
  v_perm_b32 v88, v135, v131, s65
  s_waitcnt vmcnt(3)
  buffer_load_dwordx4 v[152:155], v3, s[32:35], s66 offen
  s_add_u32 s66, s66, 8192
  s_waitcnt vmcnt(3)
  buffer_load_dwordx4 v[156:159], v3, s[32:35], s66 offen
  s_add_u32 s66, s66, 204800
  v_perm_b32 v61, v140, v136, s64
  v_perm_b32 v65, v140, v136, s65
  v_perm_b32 v69, v141, v137, s64
  v_perm_b32 v73, v141, v137, s65
  v_perm_b32 v77, v142, v138, s64
  v_perm_b32 v81, v142, v138, s65
  v_perm_b32 v85, v143, v139, s64
  v_perm_b32 v89, v143, v139, s65
  s_waitcnt vmcnt(3)
  buffer_load_dwordx4 v[160:163], v3, s[32:35], s66 offen
  s_add_u32 s66, s66, 8192
  s_waitcnt vmcnt(3)
  buffer_load_dwordx4 v[164:167], v3, s[32:35], s66 offen
  s_add_u32 s66, s66, 8192
  v_perm_b32 v62, v148, v144, s64
  v_perm_b32 v66, v148, v144, s65
  v_perm_b32 v70, v149, v145, s64
  v_perm_b32 v74, v149, v145, s65
  v_perm_b32 v78, v150, v146, s64
  v_perm_b32 v82, v150, v146, s65
  v_perm_b32 v86, v151, v147, s64
  v_perm_b32 v90, v151, v147, s65
  s_waitcnt vmcnt(3)
  buffer_load_dwordx4 v[168:171], v3, s[32:35], s66 offen
  s_add_u32 s66, s66, 8192
  s_waitcnt vmcnt(3)
  buffer_load_dwordx4 v[172:175], v3, s[32:35], s66 offen
  s_add_u32 s66, s66, 8192
  v_perm_b32 v63, v156, v152, s64
  v_perm_b32 v67, v156, v152, s65
  v_perm_b32 v71, v157, v153, s64
  v_perm_b32 v75, v157, v153, s65
  v_perm_b32 v79, v158, v154, s64
  v_perm_b32 v83, v158, v154, s65
  v_perm_b32 v87, v159, v155, s64
  v_perm_b32 v91, v159, v155, s65
  s_nop 1
  v_mfma_f32_16x16x32_bf16 v[28:31], v[60:63], v[16:19], v[28:31]
  v_mfma_f32_16x16x32_bf16 v[32:35], v[64:67], v[16:19], v[32:35]
  v_mfma_f32_16x16x32_bf16 v[36:39], v[68:71], v[16:19], v[36:39]
  v_mfma_f32_16x16x32_bf16 v[40:43], v[72:75], v[16:19], v[40:43]
  v_mfma_f32_16x16x32_bf16 v[44:47], v[76:79], v[16:19], v[44:47]
  v_mfma_f32_16x16x32_bf16 v[48:51], v[80:83], v[16:19], v[48:51]
  v_mfma_f32_16x16x32_bf16 v[52:55], v[84:87], v[16:19], v[52:55]
  v_mfma_f32_16x16x32_bf16 v[56:59], v[88:91], v[16:19], v[56:59]
  s_waitcnt vmcnt(3)
  buffer_load_dwordx4 v[176:179], v3, s[32:35], s66 offen
  s_add_u32 s66, s66, 8192
  s_waitcnt vmcnt(3)
  buffer_load_dwordx4 v[180:183], v3, s[32:35], s66 offen
  s_add_u32 s66, s66, 8192
  v_perm_b32 v60, v164, v160, s64
  v_perm_b32 v64, v164, v160, s65
  v_perm_b32 v68, v165, v161, s64
  v_perm_b32 v72, v165, v161, s65
  v_perm_b32 v76, v166, v162, s64
  v_perm_b32 v80, v166, v162, s65
  v_perm_b32 v84, v167, v163, s64
  v_perm_b32 v88, v167, v163, s65
  s_waitcnt vmcnt(3)
  s_waitcnt vmcnt(2)
  buffer_load_dwordx4 v[184:187], v3, s[32:35], s66 offen
  s_add_u32 s66, s66, 8192
  v_perm_b32 v61, v172, v168, s64
  v_perm_b32 v65, v172, v168, s65
  v_perm_b32 v69, v173, v169, s64
  v_perm_b32 v73, v173, v169, s65
  v_perm_b32 v77, v174, v170, s64
  v_perm_b32 v81, v174, v170, s65
  v_perm_b32 v85, v175, v171, s64
  v_perm_b32 v89, v175, v171, s65
  s_waitcnt vmcnt(2)
  buffer_load_dwordx4 v[188:191], v3, s[32:35], s66 offen
  s_add_u32 s66, s66, 204800
  s_waitcnt vmcnt(2)
  buffer_load_dwordx4 v[192:195], v3, s[32:35], s66 offen
  s_add_u32 s66, s66, 8192
  v_perm_b32 v62, v180, v176, s64
  v_perm_b32 v66, v180, v176, s65
  v_perm_b32 v70, v181, v177, s64
  v_perm_b32 v74, v181, v177, s65
  v_perm_b32 v78, v182, v178, s64
  v_perm_b32 v82, v182, v178, s65
  v_perm_b32 v86, v183, v179, s64
  v_perm_b32 v90, v183, v179, s65
  s_waitcnt vmcnt(2)
  buffer_load_dwordx4 v[196:199], v3, s[32:35], s66 offen
  s_add_u32 s66, s66, 8192
  s_waitcnt vmcnt(2)
  buffer_load_dwordx4 v[200:203], v3, s[32:35], s66 offen
  s_add_u32 s66, s66, 8192
  v_perm_b32 v63, v188, v184, s64
  v_perm_b32 v67, v188, v184, s65
  v_perm_b32 v71, v189, v185, s64
  v_perm_b32 v75, v189, v185, s65
  v_perm_b32 v79, v190, v186, s64
  v_perm_b32 v83, v190, v186, s65
  v_perm_b32 v87, v191, v187, s64
  v_perm_b32 v91, v191, v187, s65
  s_nop 1
  v_mfma_f32_16x16x32_bf16 v[28:31], v[60:63], v[20:23], v[28:31]
  v_mfma_f32_16x16x32_bf16 v[32:35], v[64:67], v[20:23], v[32:35]
  v_mfma_f32_16x16x32_bf16 v[36:39], v[68:71], v[20:23], v[36:39]
  v_mfma_f32_16x16x32_bf16 v[40:43], v[72:75], v[20:23], v[40:43]
  v_mfma_f32_16x16x32_bf16 v[44:47], v[76:79], v[20:23], v[44:47]
  v_mfma_f32_16x16x32_bf16 v[48:51], v[80:83], v[20:23], v[48:51]
  v_mfma_f32_16x16x32_bf16 v[52:55], v[84:87], v[20:23], v[52:55]
  v_mfma_f32_16x16x32_bf16 v[56:59], v[88:91], v[20:23], v[56:59]
  s_waitcnt vmcnt(2)
  buffer_load_dwordx4 v[204:207], v3, s[32:35], s66 offen
  s_add_u32 s66, s66, 8192
  s_waitcnt vmcnt(2)
  buffer_load_dwordx4 v[208:211], v3, s[32:35], s66 offen
  s_add_u32 s66, s66, 8192
  v_perm_b32 v60, v196, v192, s64
  v_perm_b32 v64, v196, v192, s65
  v_perm_b32 v68, v197, v193, s64
  v_perm_b32 v72, v197, v193, s65
  v_perm_b32 v76, v198, v194, s64
  v_perm_b32 v80, v198, v194, s65
  v_perm_b32 v84, v199, v195, s64
  v_perm_b32 v88, v199, v195, s65
  s_waitcnt vmcnt(2)
  buffer_load_dwordx4 v[212:215], v3, s[32:35], s66 offen
  s_add_u32 s66, s66, 8192
  s_waitcnt vmcnt(2)
  buffer_load_dwordx4 v[216:219], v3, s[32:35], s66 offen
  s_add_u32 s66, s66, 8192
  v_perm_b32 v61, v204, v200, s64
  v_perm_b32 v65, v204, v200, s65
  v_perm_b32 v69, v205, v201, s64
  v_perm_b32 v73, v205, v201, s65
  v_perm_b32 v77, v206, v202, s64
  v_perm_b32 v81, v206, v202, s65
  v_perm_b32 v85, v207, v203, s64
  v_perm_b32 v89, v207, v203, s65
  s_waitcnt vmcnt(2)
  buffer_load_dwordx4 v[220:223], v3, s[32:35], s66 offen
  s_waitcnt vmcnt(2)
  v_perm_b32 v62, v212, v208, s64
  v_perm_b32 v66, v212, v208, s65
  v_perm_b32 v70, v213, v209, s64
  v_perm_b32 v74, v213, v209, s65
  v_perm_b32 v78, v214, v210, s64
  v_perm_b32 v82, v214, v210, s65
  v_perm_b32 v86, v215, v211, s64
  v_perm_b32 v90, v215, v211, s65
  s_waitcnt vmcnt(1)
  s_waitcnt vmcnt(0)
  v_perm_b32 v63, v220, v216, s64
  v_perm_b32 v67, v220, v216, s65
  v_perm_b32 v71, v221, v217, s64
  v_perm_b32 v75, v221, v217, s65
  v_perm_b32 v79, v222, v218, s64
  v_perm_b32 v83, v222, v218, s65
  v_perm_b32 v87, v223, v219, s64
  v_perm_b32 v91, v223, v219, s65
  s_nop 1
  v_mfma_f32_16x16x32_bf16 v[28:31], v[60:63], v[24:27], v[28:31]
  v_mfma_f32_16x16x32_bf16 v[32:35], v[64:67], v[24:27], v[32:35]
  v_mfma_f32_16x16x32_bf16 v[36:39], v[68:71], v[24:27], v[36:39]
  v_mfma_f32_16x16x32_bf16 v[40:43], v[72:75], v[24:27], v[40:43]
  v_mfma_f32_16x16x32_bf16 v[44:47], v[76:79], v[24:27], v[44:47]
  v_mfma_f32_16x16x32_bf16 v[48:51], v[80:83], v[24:27], v[48:51]
  v_mfma_f32_16x16x32_bf16 v[52:55], v[84:87], v[24:27], v[52:55]
  v_mfma_f32_16x16x32_bf16 v[56:59], v[88:91], v[24:27], v[56:59]
  v_lshl_add_u32 v8, v7, 3, v6
  s_lshl_b32 s66, s52, 12
  s_add_u32 s66, s66, 131072
  v_lshl_add_u32 v8, v8, 4, s66
  s_nop 4
  s_mov_b32 exec_lo, 0x00ff00ff
  s_mov_b32 exec_hi, 0x00ff00ff
  ds_write_b128 v8, v[28:31] offset:0
  ds_write_b128 v8, v[32:35] offset:512
  ds_write_b128 v8, v[36:39] offset:1024
  ds_write_b128 v8, v[40:43] offset:1536
  ds_write_b128 v8, v[44:47] offset:2048
  ds_write_b128 v8, v[48:51] offset:2560
  ds_write_b128 v8, v[52:55] offset:3072
  ds_write_b128 v8, v[56:59] offset:3584
  s_mov_b64 exec, -1
  s_waitcnt vmcnt(0) lgkmcnt(0)
  s_barrier
  v_lshlrev_b32 v3, 15, v7
  v_lshl_add_u32 v3, v6, 4, v3
  v_add_u32 v3, s55, v3
  s_mov_b32 s51, 0
  s_mov_b32 s76, 0
  s_mov_b32 s77, 0
  s_mov_b32 s50, -1
  v_lshlrev_b32 v12, 7, v2
  v_lshlrev_b32 v13, 4, v2
  v_mov_b32 v14, 147712
  v_mov_b32 v15, 0
  v_mov_b32 v24, 0
  v_mov_b32 v25, 0
  v_mov_b32 v26, s49
  v_mov_b32 v29, 4000
  s_mov_b64 s[72:73], 0
  ds_write_b32 v14, v15
  ds_write_b64 v14, v[24:25] offset:8
  s_waitcnt lgkmcnt(0)
  s_barrier
  s_movk_i32 s66, 0
  buffer_load_dwordx4 v[224:227], v3, s[36:39], s66 offen
  s_waitcnt vmcnt(0)
  s_movk_i32 s66, 8192
  buffer_load_dwordx4 v[228:231], v3, s[36:39], s66 offen
  s_waitcnt vmcnt(0)
  v_perm_b32 v96, v228, v224, s64
  v_perm_b32 v100, v228, v224, s65
  v_perm_b32 v104, v229, v225, s64
  v_perm_b32 v108, v229, v225, s65
  v_perm_b32 v112, v230, v226, s64
  v_perm_b32 v116, v230, v226, s65
  v_perm_b32 v120, v231, v227, s64
  v_perm_b32 v124, v231, v227, s65
  s_barrier
  s_movk_i32 s66, 16384
  buffer_load_dwordx4 v[232:235], v3, s[36:39], s66 offen
  s_waitcnt vmcnt(0)
  s_movk_i32 s66, 24576
  buffer_load_dwordx4 v[236:239], v3, s[36:39], s66 offen
  s_waitcnt vmcnt(0)
  v_perm_b32 v97, v236, v232, s64
  v_perm_b32 v101, v236, v232, s65
  v_perm_b32 v105, v237, v233, s64
  v_perm_b32 v109, v237, v233, s65
  v_perm_b32 v113, v238, v234, s64
  v_perm_b32 v117, v238, v234, s65
  v_perm_b32 v121, v239, v235, s64
  v_perm_b32 v125, v239, v235, s65
  s_barrier
  s_movk_i32 s66, 4096
  buffer_load_dwordx4 v[240:243], v3, s[36:39], s66 offen
  s_waitcnt vmcnt(0)
  s_movk_i32 s66, 12288
  buffer_load_dwordx4 v[244:247], v3, s[36:39], s66 offen
  s_waitcnt vmcnt(0)
  v_perm_b32 v98, v244, v240, s64
  v_perm_b32 v102, v244, v240, s65
  v_perm_b32 v106, v245, v241, s64
  v_perm_b32 v110, v245, v241, s65
  v_perm_b32 v114, v246, v242, s64
  v_perm_b32 v118, v246, v242, s65
  v_perm_b32 v122, v247, v243, s64
  v_perm_b32 v126, v247, v243, s65
  s_barrier
  s_movk_i32 s66, 20480
  buffer_load_dwordx4 v[248:251], v3, s[36:39], s66 offen
  s_waitcnt vmcnt(0)
  s_movk_i32 s66, 28672
  buffer_load_dwordx4 v[252:255], v3, s[36:39], s66 offen
  s_waitcnt vmcnt(0)
  v_perm_b32 v99, v252, v248, s64
  v_perm_b32 v103, v252, v248, s65
  v_perm_b32 v107, v253, v249, s64
  v_perm_b32 v111, v253, v249, s65
  v_perm_b32 v115, v254, v250, s64
  v_perm_b32 v119, v254, v250, s65
  v_perm_b32 v123, v255, v251, s64
  v_perm_b32 v127, v255, v251, s65
  s_barrier
  s_movk_i32 s66, 1024
  buffer_load_dwordx4 v[224:227], v3, s[36:39], s66 offen
  s_waitcnt vmcnt(0)
  s_movk_i32 s66, 9216
  buffer_load_dwordx4 v[228:231], v3, s[36:39], s66 offen
  s_waitcnt vmcnt(0)
  v_perm_b32 v128, v228, v224, s64
  v_perm_b32 v132, v228, v224, s65
  v_perm_b32 v136, v229, v225, s64
  v_perm_b32 v140, v229, v225, s65
  v_perm_b32 v144, v230, v226, s64
  v_perm_b32 v148, v230, v226, s65
  v_perm_b32 v152, v231, v227, s64
  v_perm_b32 v156, v231, v227, s65
  s_barrier
  s_movk_i32 s66, 17408
  buffer_load_dwordx4 v[232:235], v3, s[36:39], s66 offen
  s_waitcnt vmcnt(0)
  s_movk_i32 s66, 25600
  buffer_load_dwordx4 v[236:239], v3, s[36:39], s66 offen
  s_waitcnt vmcnt(0)
  v_perm_b32 v129, v236, v232, s64
  v_perm_b32 v133, v236, v232, s65
  v_perm_b32 v137, v237, v233, s64
  v_perm_b32 v141, v237, v233, s65
  v_perm_b32 v145, v238, v234, s64
  v_perm_b32 v149, v238, v234, s65
  v_perm_b32 v153, v239, v235, s64
  v_perm_b32 v157, v239, v235, s65
  s_barrier
  s_movk_i32 s66, 5120
  buffer_load_dwordx4 v[240:243], v3, s[36:39], s66 offen
  s_waitcnt vmcnt(0)
  s_movk_i32 s66, 13312
  buffer_load_dwordx4 v[244:247], v3, s[36:39], s66 offen
  s_waitcnt vmcnt(0)
  v_perm_b32 v130, v244, v240, s64
  v_perm_b32 v134, v244, v240, s65
  v_perm_b32 v138, v245, v241, s64
  v_perm_b32 v142, v245, v241, s65
  v_perm_b32 v146, v246, v242, s64
  v_perm_b32 v150, v246, v242, s65
  v_perm_b32 v154, v247, v243, s64
  v_perm_b32 v158, v247, v243, s65
  s_barrier
  s_movk_i32 s66, 21504
  buffer_load_dwordx4 v[248:251], v3, s[36:39], s66 offen
  s_waitcnt vmcnt(0)
  s_movk_i32 s66, 29696
  buffer_load_dwordx4 v[252:255], v3, s[36:39], s66 offen
  s_waitcnt vmcnt(0)
  v_perm_b32 v131, v252, v248, s64
  v_perm_b32 v135, v252, v248, s65
  v_perm_b32 v139, v253, v249, s64
  v_perm_b32 v143, v253, v249, s65
  v_perm_b32 v147, v254, v250, s64
  v_perm_b32 v151, v254, v250, s65
  v_perm_b32 v155, v255, v251, s64
  v_perm_b32 v159, v255, v251, s65
  s_call_b64 s[96:97], L_ck
  s_barrier
  s_movk_i32 s66, 2048
  buffer_load_dwordx4 v[224:227], v3, s[36:39], s66 offen
  s_waitcnt vmcnt(0)
  s_movk_i32 s66, 10240
  buffer_load_dwordx4 v[228:231], v3, s[36:39], s66 offen
  s_waitcnt vmcnt(0)
  v_perm_b32 v160, v228, v224, s64
  v_perm_b32 v164, v228, v224, s65
  v_perm_b32 v168, v229, v225, s64
  v_perm_b32 v172, v229, v225, s65
  v_perm_b32 v176, v230, v226, s64
  v_perm_b32 v180, v230, v226, s65
  v_perm_b32 v184, v231, v227, s64
  v_perm_b32 v188, v231, v227, s65
  s_barrier
  s_movk_i32 s66, 18432
  buffer_load_dwordx4 v[232:235], v3, s[36:39], s66 offen
  s_waitcnt vmcnt(0)
  s_movk_i32 s66, 26624
  buffer_load_dwordx4 v[236:239], v3, s[36:39], s66 offen
  s_waitcnt vmcnt(0)
  v_perm_b32 v161, v236, v232, s64
  v_perm_b32 v165, v236, v232, s65
  v_perm_b32 v169, v237, v233, s64
  v_perm_b32 v173, v237, v233, s65
  v_perm_b32 v177, v238, v234, s64
  v_perm_b32 v181, v238, v234, s65
  v_perm_b32 v185, v239, v235, s64
  v_perm_b32 v189, v239, v235, s65
  s_barrier
  s_movk_i32 s66, 6144
  buffer_load_dwordx4 v[240:243], v3, s[36:39], s66 offen
  s_waitcnt vmcnt(0)
  s_movk_i32 s66, 14336
  buffer_load_dwordx4 v[244:247], v3, s[36:39], s66 offen
  s_waitcnt vmcnt(0)
  v_perm_b32 v162, v244, v240, s64
  v_perm_b32 v166, v244, v240, s65
  v_perm_b32 v170, v245, v241, s64
  v_perm_b32 v174, v245, v241, s65
  v_perm_b32 v178, v246, v242, s64
  v_perm_b32 v182, v246, v242, s65
  v_perm_b32 v186, v247, v243, s64
  v_perm_b32 v190, v247, v243, s65
  s_call_b64 s[96:97], L_ck
  s_barrier
  s_movk_i32 s66, 22528
  buffer_load_dwordx4 v[248:251], v3, s[36:39], s66 offen
  s_waitcnt vmcnt(0)
  s_movk_i32 s66, 30720
  buffer_load_dwordx4 v[252:255], v3, s[36:39], s66 offen
  s_waitcnt vmcnt(0)
  v_perm_b32 v163, v252, v248, s64
  v_perm_b32 v167, v252, v248, s65
  v_perm_b32 v171, v253, v249, s64
  v_perm_b32 v175, v253, v249, s65
  v_perm_b32 v179, v254, v250, s64
  v_perm_b32 v183, v254, v250, s65
  v_perm_b32 v187, v255, v251, s64
  v_perm_b32 v191, v255, v251, s65
  s_barrier
  s_movk_i32 s66, 3072
  buffer_load_dwordx4 v[224:227], v3, s[36:39], s66 offen
  s_waitcnt vmcnt(0)
  s_movk_i32 s66, 11264
  buffer_load_dwordx4 v[228:231], v3, s[36:39], s66 offen
  s_waitcnt vmcnt(0)
  v_perm_b32 v192, v228, v224, s64
  v_perm_b32 v196, v228, v224, s65
  v_perm_b32 v200, v229, v225, s64
  v_perm_b32 v204, v229, v225, s65
  v_perm_b32 v208, v230, v226, s64
  v_perm_b32 v212, v230, v226, s65
  v_perm_b32 v216, v231, v227, s64
  v_perm_b32 v220, v231, v227, s65
  s_call_b64 s[96:97], L_ck
  s_barrier
  s_movk_i32 s66, 19456
  buffer_load_dwordx4 v[232:235], v3, s[36:39], s66 offen
  s_waitcnt vmcnt(0)
  s_movk_i32 s66, 27648
  buffer_load_dwordx4 v[236:239], v3, s[36:39], s66 offen
  s_waitcnt vmcnt(0)
  v_perm_b32 v193, v236, v232, s64
  v_perm_b32 v197, v236, v232, s65
  v_perm_b32 v201, v237, v233, s64
  v_perm_b32 v205, v237, v233, s65
  v_perm_b32 v209, v238, v234, s64
  v_perm_b32 v213, v238, v234, s65
  v_perm_b32 v217, v239, v235, s64
  v_perm_b32 v221, v239, v235, s65
  s_barrier
  s_movk_i32 s66, 7168
  buffer_load_dwordx4 v[240:243], v3, s[36:39], s66 offen
  s_waitcnt vmcnt(0)
  s_movk_i32 s66, 15360
  buffer_load_dwordx4 v[244:247], v3, s[36:39], s66 offen
  s_waitcnt vmcnt(0)
  v_perm_b32 v194, v244, v240, s64
  v_perm_b32 v198, v244, v240, s65
  v_perm_b32 v202, v245, v241, s64
  v_perm_b32 v206, v245, v241, s65
  v_perm_b32 v210, v246, v242, s64
  v_perm_b32 v214, v246, v242, s65
  v_perm_b32 v218, v247, v243, s64
  v_perm_b32 v222, v247, v243, s65
  s_barrier
  s_movk_i32 s66, 23552
  buffer_load_dwordx4 v[248:251], v3, s[36:39], s66 offen
  s_waitcnt vmcnt(0)
  s_movk_i32 s66, 31744
  buffer_load_dwordx4 v[252:255], v3, s[36:39], s66 offen
  s_waitcnt vmcnt(0)
  v_perm_b32 v195, v252, v248, s64
  v_perm_b32 v199, v252, v248, s65
  v_perm_b32 v203, v253, v249, s64
  v_perm_b32 v207, v253, v249, s65
  v_perm_b32 v211, v254, v250, s64
  v_perm_b32 v215, v254, v250, s65
  v_perm_b32 v219, v255, v251, s64
  v_perm_b32 v223, v255, v251, s65
  s_call_b64 s[96:97], L_ck
  s_barrier
  s_barrier
  s_barrier
  s_call_b64 s[96:97], L_ck
  s_barrier
  v_and_b32 v8, 7, v2
  v_lshl_add_u32 v5, v7, 3, v8
  v_lshlrev_b32 v5, 4, v5
  v_lshlrev_b32 v3, 4, v2
  v_and_b32 v5, 0xff, v5
  v_lshrrev_b32 v9, 5, v2
  v_lshl_add_u32 v5, v9, 13, v5
  v_and_b32 v9, 8, v2
  v_lshl_add_u32 v5, v9, 24, v5
  s_lshl_b32 s66, s53, 18
  s_lshl_b32 s67, s52, 16
  s_add_u32 s66, s66, s67
  s_lshl_b32 s67, s54, 8
  s_add_u32 s66, s66, s67
  s_add_u32 s66, s66, 0x100000
  s_add_u32 s68, s66, 0
  s_add_u32 s69, s66, 16384
  s_add_u32 s70, s66, 32768
  s_add_u32 s71, s66, 49152
  s_branch L_ckdone
L_ck:
  s_barrier
  s_cmp_eq_u32 s52, 3
  s_cbranch_scc1 L_ckwork
  s_cmp_lg_u32 s51, 1
  s_cbranch_scc1 L_cknext
  s_barrier
  s_branch L_cknext
L_ckwork:
  s_memrealtime s[60:61]
  s_lshl_b32 s56, s51, 15
  s_add_u32 s56, s56, 0x80000
  s_cmp_eq_u32 s51, 0
  s_cbranch_scc1 L_nogather
  s_and_b32 s57, s2, 0xc0
  s_lshl_b32 s57, s57, 7
  s_add_u32 s57, s57, s56
  s_sub_u32 s57, s57, 0x8000
  buffer_load_dwordx2 v[24:25], v12, s[40:43], s57 offen
L_nogather:
  s_waitcnt lgkmcnt(0)
  v_mov_b32 v16, s60
  v_mov_b32 v17, s61
  v_mov_b32 v18, s60
  v_mov_b32 v19, s61
  s_lshl_b32 s57, s2, 7
  s_add_u32 s57, s57, s56
  s_mov_b64 exec, 0xff
  buffer_store_dwordx4 v[16:19], v13, s[40:43], s57 offen sc1
  s_mov_b64 exec, -1
  s_cmp_lg_u32 s51, 1
  s_cbranch_scc1 L_cknomid
  s_barrier
L_cknomid:
  s_waitcnt vmcnt(0)
  v_subrev_co_u32 v20, vcc, s48, v24
  s_nop 1
  v_subb_co_u32 v21, vcc, v25, v26, vcc
  v_cmp_lt_i32 s[74:75], 64, v20
  v_cmp_eq_u32 vcc, 0, v21
  s_and_b64 vcc, vcc, s[74:75]
  s_or_b64 s[72:73], s[72:73], vcc
  v_subrev_u32 v15, s76, v24
  v_add_u32 v20, 2000, v15
  v_cmp_gt_u32 s[74:75], v29, v20
  s_and_b64 vcc, vcc, s[74:75]
  v_cndmask_b32 v15, 0, v15, vcc
  s_nop 1
  v_add_u32_dpp v15, v15, v15 row_ror:1 row_mask:0xf bank_mask:0xf
  s_nop 1
  v_add_u32_dpp v15, v15, v15 row_ror:2 row_mask:0xf bank_mask:0xf
  s_nop 1
  v_add_u32_dpp v15, v15, v15 row_ror:4 row_mask:0xf bank_mask:0xf
  s_nop 1
  v_add_u32_dpp v15, v15, v15 row_ror:8 row_mask:0xf bank_mask:0xf
  s_nop 1
  v_readlane_b32 s57, v15, 0
  v_readlane_b32 s58, v15, 16
  v_readlane_b32 s66, v15, 32
  v_readlane_b32 s67, v15, 48
  s_add_i32 s57, s57, s58
  s_add_i32 s66, s66, s67
  s_add_i32 s57, s57, s66
  s_ashr_i32 s57, s57, 6
  s_add_u32 s58, s76, s57
  s_sub_u32 s66, s58, s77
  s_cmp_ge_u32 s51, 2
  s_cselect_b32 s66, s66, -1
  s_min_u32 s50, s50, s66
  s_add_u32 s66, s58, s50
  s_sub_u32 s66, s60, s66
  s_sub_i32 s67, 0, s57
  s_cmp_lt_u32 s51, 2
  s_cselect_b32 s66, s67, s66
  s_mov_b32 s77, s58
  s_mov_b32 s76, s60
  s_add_i32 s66, s66, 22
  s_max_i32 s66, s66, 0
  s_min_i32 s66, s66, 204
  s_mul_i32 s66, s66, 43
  s_lshr_b32 s66, s66, 10
  v_mov_b32 v21, s66
  ds_write_b32 v14, v21
  s_waitcnt vmcnt(0) lgkmcnt(0)
L_cknext:
  s_add_u32 s51, s51, 1
  s_setpc_b64 s[96:97]
L_ckdone:
  s_cmp_lg_u32 s52, 3
  s_cbranch_scc1 L_cdone
  s_mov_b32 s51, 0x40000
  s_and_b32 s57, s2, 0xc0
  s_lshl_b32 s57, s57, 7
  s_add_u32 s57, s57, 0xa0000
  buffer_load_dwordx2 v[24:25], v12, s[40:43], s57 offen
  s_waitcnt vmcnt(0)
  v_subrev_co_u32 v20, vcc, s48, v24
  s_nop 1
  v_subb_co_u32 v21, vcc, v25, v26, vcc
  v_cmp_lt_i32 s[74:75], 64, v20
  v_cmp_eq_u32 vcc, 0, v21
  s_and_b64 vcc, vcc, s[74:75]
  s_or_b64 s[72:73], s[72:73], vcc
  v_subrev_u32 v15, s76, v24
  v_add_u32 v20, 2000, v15
  v_cmp_gt_u32 s[74:75], v29, v20
  s_and_b64 vcc, vcc, s[74:75]
  v_cndmask_b32 v15, 0, v15, vcc
  s_nop 1
  v_add_u32_dpp v15, v15, v15 row_ror:1 row_mask:0xf bank_mask:0xf
  s_nop 1
  v_add_u32_dpp v15, v15, v15 row_ror:2 row_mask:0xf bank_mask:0xf
  s_nop 1
  v_add_u32_dpp v15, v15, v15 row_ror:4 row_mask:0xf bank_mask:0xf
  s_nop 1
  v_add_u32_dpp v15, v15, v15 row_ror:8 row_mask:0xf bank_mask:0xf
  s_nop 1
  v_readlane_b32 s56, v15, 0
  v_readlane_b32 s58, v15, 16
  v_readlane_b32 s66, v15, 32
  v_readlane_b32 s67, v15, 48
  s_add_i32 s56, s56, s58
  s_add_i32 s66, s66, s67
  s_add_i32 s56, s56, s66
  s_ashr_i32 s56, s56, 6
  s_add_u32 s56, s56, s76
  s_lshr_b32 s66, s50, 1
  s_add_u32 s56, s56, s66
  s_sub_u32 s56, s56, 5
  s_lshr_b32 s66, s50, 3
  v_mov_b32 v20, s56
  v_mov_b32 v21, s66
  ds_write_b64 v14, v[20:21] offset:8
  s_waitcnt lgkmcnt(0)
L_cspin:
  s_bitcmp1_b32 s53, 0
  s_cselect_b32 s66, s73, s72
  s_cmp_eq_u32 s66, -1
  s_cbranch_scc1 L_cdone
  s_sleep 32
  buffer_load_dwordx2 v[24:25], v12, s[40:43], s57 offen sc1
  s_waitcnt vmcnt(0)
  v_subrev_co_u32 v20, vcc, s48, v24
  s_nop 1
  v_subb_co_u32 v21, vcc, v25, v26, vcc
  v_cmp_lt_i32 s[74:75], 64, v20
  v_cmp_eq_u32 vcc, 0, v21
  s_and_b64 vcc, vcc, s[74:75]
  s_or_b64 s[72:73], s[72:73], vcc
  s_sub_u32 s51, s51, 1
  s_cmp_lg_u32 s51, 0
  s_cbranch_scc1 L_cspin
L_cdone:
  s_barrier
  s_barrier
  s_barrier
L_ep:
  ds_read_b128 v[44:47], v3 offset:0
  ds_read_b128 v[48:51], v3 offset:4096
  ds_read_b128 v[52:55], v3 offset:8192
  ds_read_b128 v[56:59], v3 offset:12288
  ds_read_b128 v[60:63], v3 offset:1024
  ds_read_b128 v[64:67], v3 offset:5120
  ds_read_b128 v[68:71], v3 offset:9216
  ds_read_b128 v[72:75], v3 offset:13312
  s_waitcnt lgkmcnt(6)
  v_pk_add_f32 v[44:45], v[44:45], v[48:49]
  v_pk_add_f32 v[46:47], v[46:47], v[50:51]
  s_waitcnt lgkmcnt(4)
  v_pk_add_f32 v[52:53], v[52:53], v[56:57]
  v_pk_add_f32 v[54:55], v[54:55], v[58:59]
  v_pk_add_f32 v[44:45], v[44:45], v[52:53]
  v_pk_add_f32 v[46:47], v[46:47], v[54:55]
  v_cvt_pk_bf16_f32 v224, v44, v45
  v_cvt_pk_bf16_f32 v225, v46, v47
  s_nop 1
  v_mov_b32_dpp v226, v224 row_ror:8 row_mask:0xf bank_mask:0xf
  v_mov_b32_dpp v227, v225 row_ror:8 row_mask:0xf bank_mask:0xf
  ds_read_b128 v[76:79], v3 offset:2048
  ds_read_b128 v[80:83], v3 offset:6144
  v_mfma_f32_16x16x32_bf16 v[12:15], v[96:99], v[224:227], 0
  ds_read_b128 v[84:87], v3 offset:10240
  ds_read_b128 v[88:91], v3 offset:14336
  ds_read_b128 v[44:47], v3 offset:3072
  ds_read_b128 v[48:51], v3 offset:7168
  v_mfma_f32_16x16x32_bf16 v[16:19], v[100:103], v[224:227], 0
  ds_read_b128 v[52:55], v3 offset:11264
  ds_read_b128 v[56:59], v3 offset:15360
  s_waitcnt lgkmcnt(8)
  v_mfma_f32_16x16x32_bf16 v[20:23], v[104:107], v[224:227], 0
  v_add_f32 v60, v60, v64
  v_add_f32 v61, v61, v65
  v_add_f32 v62, v62, v66
  v_add_f32 v63, v63, v67
  v_mfma_f32_16x16x32_bf16 v[24:27], v[108:111], v[224:227], 0
  v_add_f32 v68, v68, v72
  v_add_f32 v69, v69, v73
  v_add_f32 v70, v70, v74
  v_mfma_f32_16x16x32_bf16 v[28:31], v[112:115], v[224:227], 0
  v_add_f32 v71, v71, v75
  v_add_f32 v60, v60, v68
  v_add_f32 v61, v61, v69
  v_add_f32 v62, v62, v70
  v_mfma_f32_16x16x32_bf16 v[32:35], v[116:119], v[224:227], 0
  v_add_f32 v63, v63, v71
  v_cvt_pk_bf16_f32 v228, v60, v61
  v_cvt_pk_bf16_f32 v229, v62, v63
  v_mfma_f32_16x16x32_bf16 v[36:39], v[120:123], v[224:227], 0
  s_nop 1
  v_mov_b32_dpp v230, v228 row_ror:8 row_mask:0xf bank_mask:0xf
  v_mov_b32_dpp v231, v229 row_ror:8 row_mask:0xf bank_mask:0xf
  v_mfma_f32_16x16x32_bf16 v[40:43], v[124:127], v[224:227], 0
  s_nop 0
  v_mfma_f32_16x16x32_bf16 v[12:15], v[128:131], v[228:231], v[12:15]
  s_waitcnt lgkmcnt(4)
  v_add_f32 v76, v76, v80
  v_add_f32 v77, v77, v81
  v_mfma_f32_16x16x32_bf16 v[16:19], v[132:135], v[228:231], v[16:19]
  v_add_f32 v78, v78, v82
  v_add_f32 v79, v79, v83
  v_add_f32 v84, v84, v88
  v_mfma_f32_16x16x32_bf16 v[20:23], v[136:139], v[228:231], v[20:23]
  v_add_f32 v85, v85, v89
  v_add_f32 v86, v86, v90
  v_add_f32 v87, v87, v91
  v_mfma_f32_16x16x32_bf16 v[24:27], v[140:143], v[228:231], v[24:27]
  v_add_f32 v76, v76, v84
  v_add_f32 v77, v77, v85
  v_add_f32 v78, v78, v86
  v_mfma_f32_16x16x32_bf16 v[28:31], v[144:147], v[228:231], v[28:31]
  v_add_f32 v79, v79, v87
  v_cvt_pk_bf16_f32 v232, v76, v77
  v_cvt_pk_bf16_f32 v233, v78, v79
  v_mfma_f32_16x16x32_bf16 v[32:35], v[148:151], v[228:231], v[32:35]
  s_nop 1
  v_mov_b32_dpp v234, v232 row_ror:8 row_mask:0xf bank_mask:0xf
  v_mov_b32_dpp v235, v233 row_ror:8 row_mask:0xf bank_mask:0xf
  v_mfma_f32_16x16x32_bf16 v[36:39], v[152:155], v[228:231], v[36:39]
  s_waitcnt lgkmcnt(0)
  v_add_f32 v44, v44, v48
  v_add_f32 v45, v45, v49
  v_add_f32 v46, v46, v50
  v_mfma_f32_16x16x32_bf16 v[40:43], v[156:159], v[228:231], v[40:43]
  v_add_f32 v47, v47, v51
  v_add_f32 v52, v52, v56
  v_add_f32 v53, v53, v57
  v_add_f32 v54, v54, v58
  v_mfma_f32_16x16x32_bf16 v[12:15], v[160:163], v[232:235], v[12:15]
  v_add_f32 v55, v55, v59
  v_add_f32 v44, v44, v52
  v_add_f32 v45, v45, v53
  v_mfma_f32_16x16x32_bf16 v[16:19], v[164:167], v[232:235], v[16:19]
  v_add_f32 v46, v46, v54
  v_add_f32 v47, v47, v55
  v_cvt_pk_bf16_f32 v236, v44, v45
  v_cvt_pk_bf16_f32 v237, v46, v47
  v_mfma_f32_16x16x32_bf16 v[20:23], v[168:171], v[232:235], v[20:23]
  s_nop 1
  v_mov_b32_dpp v238, v236 row_ror:8 row_mask:0xf bank_mask:0xf
  v_mov_b32_dpp v239, v237 row_ror:8 row_mask:0xf bank_mask:0xf
  v_mfma_f32_16x16x32_bf16 v[24:27], v[172:175], v[232:235], v[24:27]
  s_nop 0
  v_mfma_f32_16x16x32_bf16 v[12:15], v[192:195], v[236:239], v[12:15]
  v_mfma_f32_16x16x32_bf16 v[16:19], v[196:199], v[236:239], v[16:19]
  v_mfma_f32_16x16x32_bf16 v[20:23], v[200:203], v[236:239], v[20:23]
  s_nop 1
  v_mfma_f32_16x16x32_bf16 v[24:27], v[204:207], v[236:239], v[24:27]
  s_nop 1
  v_mfma_f32_16x16x32_bf16 v[28:31], v[176:179], v[232:235], v[28:31]
  s_nop 0
  v_mfma_f32_16x16x32_bf16 v[32:35], v[180:183], v[232:235], v[32:35]
  v_cvt_pk_bf16_f32 v240, v12, v16
  v_cvt_pk_bf16_f32 v241, v13, v17
  v_cvt_pk_bf16_f32 v242, v14, v18
  v_mfma_f32_16x16x32_bf16 v[28:31], v[208:211], v[236:239], v[28:31]
  v_cvt_pk_bf16_f32 v243, v15, v19
  v_min_u32 v240, -2, v240
  v_min_u32 v241, -2, v241
  v_mfma_f32_16x16x32_bf16 v[32:35], v[212:215], v[236:239], v[32:35]
  v_min_u32 v242, -2, v242
  v_min_u32 v243, -2, v243
  v_mfma_f32_16x16x32_bf16 v[36:39], v[184:187], v[232:235], v[36:39]
  buffer_store_dwordx4 v[240:243], v5, s[40:43], s68 offen sc1
  v_cvt_pk_bf16_f32 v244, v20, v24
  v_cvt_pk_bf16_f32 v245, v21, v25
  v_mfma_f32_16x16x32_bf16 v[40:43], v[188:191], v[232:235], v[40:43]
  v_cvt_pk_bf16_f32 v246, v22, v26
  v_cvt_pk_bf16_f32 v247, v23, v27
  v_mfma_f32_16x16x32_bf16 v[36:39], v[216:219], v[236:239], v[36:39]
  v_min_u32 v244, -2, v244
  v_min_u32 v245, -2, v245
  v_min_u32 v246, -2, v246
  v_mfma_f32_16x16x32_bf16 v[40:43], v[220:223], v[236:239], v[40:43]
  v_min_u32 v247, -2, v247
  buffer_store_dwordx4 v[244:247], v5, s[40:43], s69 offen sc1
  v_cvt_pk_bf16_f32 v248, v28, v32
  v_cvt_pk_bf16_f32 v249, v29, v33
  v_cvt_pk_bf16_f32 v250, v30, v34
  v_cvt_pk_bf16_f32 v251, v31, v35
  v_min_u32 v248, -2, v248
  v_min_u32 v249, -2, v249
  v_min_u32 v250, -2, v250
  v_min_u32 v251, -2, v251
  buffer_store_dwordx4 v[248:251], v5, s[40:43], s70 offen sc1
  v_cvt_pk_bf16_f32 v252, v36, v40
  v_cvt_pk_bf16_f32 v253, v37, v41
  v_cvt_pk_bf16_f32 v254, v38, v42
  v_cvt_pk_bf16_f32 v255, v39, v43
  v_min_u32 v252, -2, v252
  v_min_u32 v253, -2, v253
  v_min_u32 v254, -2, v254
  v_min_u32 v255, -2, v255
  buffer_store_dwordx4 v[252:255], v5, s[40:43], s71 offen sc1
  s_waitcnt vmcnt(0)
  s_barrier
L_end:
  s_endpgm
.section .rodata,"a"
.p2align 6
.amdhsa_kernel standalone__mha_block_cached__sampling_kernel
  .amdhsa_next_free_vgpr 256
  .amdhsa_next_free_sgpr 102
  .amdhsa_accum_offset 256
  .amdhsa_group_segment_fixed_size 0
  .amdhsa_kernarg_size 64
  .amdhsa_user_sgpr_count 2
  .amdhsa_user_sgpr_kernarg_segment_ptr 1
  .amdhsa_system_sgpr_workgroup_id_x 1
.end_amdhsa_kernel
```
